```python
import torch

def _softmax(x, axis=-1):
    return torch.softmax(x, dim=axis)
def _gelu(x):
    return torch.nn.functional.gelu(x, approximate="tanh")
def _silu(x):
    return torch.nn.functional.silu(x)
def _sigmoid(x):
    return torch.sigmoid(x)
def _layernorm(x, axis=-1, eps=1e-5):
    m = x.mean(dim=axis, keepdim=True)
    v = x.var(dim=axis, keepdim=True, unbiased=False)
    return (x - m) / torch.sqrt(v + eps)
def _scatter_add(tgt, idx, src, axis=0):
    return tgt.clone().index_add_(axis, idx, src)
def _segment_sum(src, seg, n):
    out = torch.zeros((n,) + src.shape[1:], dtype=src.dtype)
    return out.index_add_(0, seg, src)
def _pad(x, pw):
    flat = tuple(v for pair in reversed(pw) for v in pair)
    return torch.nn.functional.pad(x, flat)

kernel_name = 'recurrent_scan__linear_attn_block__dense_activation_relu__prompt'

def setup_inputs():

    _w = (lambda a: (lambda t: t.to(torch.bfloat16) if t.is_floating_point() else t)(torch.as_tensor(a)))
    def _A_setup():
        B, S, D = 1, 2048, 512
        return {
            "x": _w((lambda *s: torch.randn(*s, dtype=torch.bfloat16) * 0.05)(B, S, D)),
            "wqkv": _w((lambda *s: torch.randn(*s, dtype=torch.bfloat16) * 0.05)(D, 3 * D)),
            "wo": _w((lambda *s: torch.randn(*s, dtype=torch.bfloat16) * 0.05)(D, D)),
        }
    _A_in = _A_setup()

    def _B_setup():
        B, S, D, Dff = 1, 2048, 512, 1792
        return {
            "x": _w((lambda *s: torch.randn(*s, dtype=torch.bfloat16) * 0.05)(B, S, D)),
            "w1": _w((lambda *s: torch.randn(*s, dtype=torch.bfloat16) * 0.05)(D, Dff)),
            "w2": _w((lambda *s: torch.randn(*s, dtype=torch.bfloat16) * 0.05)(Dff, D)),
        }
    _B_in = _B_setup()

    return {
        "A_x": _A_in["x"],
        "A_wqkv": _A_in["wqkv"],
        "A_wo": _A_in["wo"],
        "B_x": _B_in["x"],
        "B_w1": _B_in["w1"],
        "B_w2": _B_in["w2"],
    }

def reference(A_x, A_wqkv, A_wo, B_x, B_w1, B_w2):
    def _A_ref(x, wqkv, wo):
        B, S, D = x.shape
        H = 32; Dh = D // H
        qkv = (lambda x, *d: x.permute(*d))((x @ wqkv).reshape(B, S, 3, H, Dh), 2, 0, 3, 1, 4)
        q, k, v = qkv[0], qkv[1], qkv[2]
        phi = lambda t: torch.where(t > 0, t + 1, torch.exp(t)) + 1e-6
        pq, pk = phi(q), phi(k)
        kv = torch.einsum("bhsd,bhse->bhde", pk, v)
        z = torch.einsum("bhsd->bhd", pk)
        num = torch.einsum("bhqd,bhde->bhqe", pq, kv)
        den = torch.einsum("bhqd,bhd->bhq", pq, z)[..., None] + 1e-6
        o = num / den
        return (lambda x, *d: x.permute(*d))(o, 0, 2, 1, 3).reshape(B, S, D) @ wo

    def _B_ref(x, w1, w2):
        h = torch.einsum("bsd,df->bsf", x, w1)
        zero = torch.zeros_like(h)
        h = torch.maximum(h, zero)
        return torch.einsum("bsf,fd->bsd", h, w2)

    x = A_x
    xn = _layernorm(x, axis=-1)
    s = _A_ref(xn, A_wqkv, A_wo)
    g = _silu(_B_ref(xn, B_w1, B_w2))
    return x + s * g
```

```asm
; @launch grid=(256,1,1) block=(256,1,1) lds=163840
.amdgcn_target "amdgcn-amd-amdhsa--gfx950"
.text
.globl recurrent_scan__linear_attn_block__dense_activation_relu__prompt_kernel
.p2align 8
.type recurrent_scan__linear_attn_block__dense_activation_relu__prompt_kernel,@function
recurrent_scan__linear_attn_block__dense_activation_relu__prompt_kernel:
s_load_dwordx4 s[4:7], s[0:1], 0
s_load_dwordx4 s[12:15], s[0:1], 32
s_load_dwordx2 s[10:11], s[0:1], 64
s_load_dwordx4 s[36:39], s[0:1], 48
s_load_dwordx2 s[8:9], s[0:1], 16
s_cmp_ge_u32 s2, 256
s_cbranch_scc1 L_end
v_lshrrev_b32 v2, 6, v0
v_and_b32 v1, 63, v0
s_and_b32 s62, s2, 7
s_lshr_b32 s63, s2, 3
v_readfirstlane_b32 s40, v2
s_and_b32 s43, s62, 1
s_lshl_b32 s43, s43, 3
s_and_b32 s64, s63, 7
s_add_u32 s43, s43, s64
s_and_b32 s44, s62, 6
s_lshr_b32 s64, s63, 4
s_add_u32 s44, s44, s64
s_bfe_u32 s45, s63, 0x10003
s_lshl_b32 s46, s62, 2
s_and_b32 s64, s63, 3
s_add_u32 s46, s46, s64
s_lshr_b32 s47, s63, 2
s_lshr_b32 s41, s40, 1
s_and_b32 s42, s40, 1
s_lshr_b32 s64, s44, 1
s_add_u32 s49, s43, s64
s_and_b32 s49, s49, 3
s_mul_i32 s48, s49, 2
s_getpc_b64 s[66:67]
L_pc:
s_lshl_b32 s64, s63, 2
s_add_u32 s64, s64, s40
s_mul_i32 s64, s64, 384
v_min_u32 v3, 2, v1
v_lshlrev_b32 v3, 7, v3
v_add_u32 v3, s64, v3
v_min_u32 v3, L_end-L_pc, v3
v_lshrrev_b32 v4, 3, v1
v_and_b32 v5, 7, v1
v_xor_b32 v6, v5, v4
v_lshlrev_b32 v6, 4, v6
v_lshl_add_u32 v6, v4, 10, v6
s_lshl_b32 s64, s40, 15
v_add_u32 v100, s64, v6
v_add_u32 v101, 7168, v100
v_add_u32 v102, 14336, v100
v_add_u32 v103, 21504, v100
s_lshl_b32 s64, s45, 3
s_add_u32 s64, s64, s44
s_lshl_b32 s64, s64, 3
s_lshl_b32 s65, s40, 1
s_add_u32 s64, s64, s65
s_lshl_b32 s65, s43, 7
s_add_u32 s68, s64, s65
s_lshl_b32 s69, s68, 10
v_lshrrev_b32 v7, 5, v1
v_and_b32 v8, 31, v1
v_lshlrev_b32 v9, 4, v8
v_lshl_add_u32 v9, v7, 10, v9
s_lshl_b32 s58, s43, 17
s_lshl_b32 s53, s40, 12
s_waitcnt lgkmcnt(0)
s_mov_b32 s16, s4
s_mov_b32 s17, s5
s_mov_b32 s18, 0x200000
s_mov_b32 s19, 0x20000
buffer_load_dwordx4 v[32:35], v9, s[16:19], s69 offen
buffer_load_dwordx4 v[36:39], v9, s[16:19], s69 offen offset:512
s_lshl_b32 s50, s48, 7
s_add_u32 s50, s50, s58
s_mov_b32 m0, s53
s_nop 0
buffer_load_dwordx4 v100, s[16:19], s50 offen offset:0 lds
buffer_load_dwordx4 v101, s[16:19], s50 offen offset:1024 lds
buffer_load_dwordx4 v102, s[16:19], s50 offen offset:2048 lds
buffer_load_dwordx4 v103, s[16:19], s50 offen offset:3072 lds
s_mov_b32 s24, s10
s_mov_b32 s25, s11
s_mov_b32 s26, 0x10000000
s_mov_b32 s27, 0x20000
s_mov_b32 s28, s38
s_mov_b32 s29, s39
s_mov_b32 s30, 0x100
s_mov_b32 s31, 0x20000
s_cmp_lg_u32 s2, 0
s_cbranch_scc1 L_nononce
s_cmp_lg_u32 s40, 0
s_cbranch_scc1 L_nononce
s_memrealtime s[64:65]
s_waitcnt lgkmcnt(0)
s_and_b32 s65, s64, 0x3fff
s_lshl_b32 s64, s64, 2
s_and_b32 s64, s64, 0x3fff0000
s_or_b32 s64, s64, s65
s_or_b32 s64, s64, 0x80000000
v_mov_b32 v10, s64
v_mov_b32 v11, 0
s_mov_b64 exec, 1
buffer_store_dword v10, v11, s[28:31], 0 offen sc1
s_mov_b64 exec, -1
L_nononce:
s_cmp_lg_u32 s45, 0
s_cbranch_scc1 L_qkv
s_mov_b32 s20, s12
s_mov_b32 s21, s13
s_mov_b32 s22, 0x1c0000
s_mov_b32 s23, 0x20000
s_mul_i32 s59, s44, 448
s_and_b32 s59, s59, 0xffffff80
s_lshl_b32 s54, s40, 13
s_add_u32 s54, s54, 16384
v_lshlrev_b32 v10, 1, v7
v_xor_b32 v10, v8, v10
v_lshlrev_b32 v10, 4, v10
v_mul_u32_u24 v11, 3584, v7
s_mul_i32 s64, s40, 57344
v_add_u32 v11, s64, v11
s_bitcmp1_b32 s44, 0
s_cselect_b32 s64, 0, 7
v_lshrrev_b32 v13, 6, v10
v_xor_b32 v13, s64, v13
v_mov_b32 v14, 0x40000000
v_cmp_eq_u32 vcc, 0, v13
v_add_u32 v12, v11, v10
v_cndmask_b32 v12, v12, v14, vcc
v_add_u32 v104, 0, v12
v_add_u32 v106, 12288, v12
v_cmp_eq_u32 vcc, 1, v13
v_xor_b32 v12, 64, v10
v_add_u32 v12, v11, v12
v_cndmask_b32 v12, v12, v14, vcc
v_add_u32 v105, 6144, v12
v_add_u32 v107, 18432, v12
v_cmp_eq_u32 vcc, 2, v13
v_xor_b32 v12, 128, v10
v_add_u32 v12, v11, v12
v_cndmask_b32 v12, v12, v14, vcc
v_add_u32 v108, 28672, v12
v_add_u32 v110, 40960, v12
v_cmp_eq_u32 vcc, 3, v13
v_xor_b32 v12, 192, v10
v_add_u32 v12, v11, v12
v_cndmask_b32 v12, v12, v14, vcc
v_add_u32 v109, 34816, v12
v_add_u32 v111, 47104, v12
s_lshl_b32 s50, s48, 7
s_add_u32 s50, s50, s58
s_mul_i32 s51, s48, 229376
s_add_u32 s51, s51, s59
s_add_u32 s48, s48, 1
s_and_b32 s48, s48, 7
s_add_u32 m0, s54, 0
s_nop 0
buffer_load_dwordx4 v104, s[20:23], s51 offen offset:0 lds
buffer_load_dwordx4 v105, s[20:23], s51 offen offset:1024 lds
buffer_load_dwordx4 v106, s[20:23], s51 offen offset:2048 lds
buffer_load_dwordx4 v107, s[20:23], s51 offen offset:3072 lds
s_add_u32 m0, s54, 4096
s_nop 0
buffer_load_dwordx4 v108, s[20:23], s51 offen offset:0 lds
buffer_load_dwordx4 v109, s[20:23], s51 offen offset:1024 lds
buffer_load_dwordx4 v110, s[20:23], s51 offen offset:2048 lds
buffer_load_dwordx4 v111, s[20:23], s51 offen offset:3072 lds
global_load_dword v2, v3, s[66:67]
s_lshl_b32 s64, s41, 13
v_and_b32 v10, 15, v1
v_lshrrev_b32 v11, 4, v1
v_xor_b32 v12, v11, v5
v_lshlrev_b32 v12, 4, v12
v_lshl_add_u32 v12, v10, 7, v12
v_add_u32 v116, s64, v12
v_xor_b32 v117, 64, v116
v_bfe_u32 v12, v1, 2, 2
v_and_b32 v13, 3, v1
v_lshlrev_b32 v13, 3, v13
s_mul_i32 s64, s42, 7
s_and_b32 s65, s44, 1
s_lshl_b32 s65, s65, 1
s_add_u32 s64, s64, s65
v_and_b32 v14, 1, v11
v_lshl_or_b32 v14, v14, 2, v12
v_lshl_add_u32 v15, v11, 3, v12
v_lshl_add_u32 v15, v15, 9, v13
v_add_u32 v15, 16384, v15
s_add_u32 s65, s64, 0
v_xor_b32 v16, s65, v14
v_lshl_add_u32 v118, v16, 5, v15
s_add_u32 s65, s64, 1
v_xor_b32 v16, s65, v14
v_lshl_add_u32 v119, v16, 5, v15
s_add_u32 s65, s64, 2
v_xor_b32 v16, s65, v14
v_lshl_add_u32 v120, v16, 5, v15
s_add_u32 s65, s64, 3
v_xor_b32 v16, s65, v14
v_lshl_add_u32 v121, v16, 5, v15
s_add_u32 s65, s64, 4
v_xor_b32 v16, s65, v14
v_lshl_add_u32 v122, v16, 5, v15
s_add_u32 s65, s64, 5
v_xor_b32 v16, s65, v14
v_lshl_add_u32 v123, v16, 5, v15
s_add_u32 s65, s64, 6
v_xor_b32 v16, s65, v14
v_lshl_add_u32 v124, v16, 5, v15
v_add_u32 v125, 49152, v116
v_add_u32 v126, 49152, v117
v_add_u32 v127, 49152, v118
v_add_u32 v240, 49152, v119
v_add_u32 v241, 49152, v120
v_add_u32 v242, 49152, v121
v_add_u32 v243, 49152, v122
v_add_u32 v244, 49152, v123
v_add_u32 v245, 49152, v124
v_add_u32 v246, 98304, v116
v_add_u32 v247, 98304, v117
v_add_u32 v248, 98304, v118
v_add_u32 v249, 98304, v119
v_add_u32 v250, 98304, v120
v_add_u32 v251, 98304, v121
v_add_u32 v252, 98304, v122
v_add_u32 v253, 98304, v123
v_add_u32 v254, 98304, v124
v_bfe_u32 v14, v1, 4, 2
v_lshlrev_b32 v14, 1, v14
v_xor_b32 v14, v5, v14
v_lshlrev_b32 v14, 4, v14
v_lshl_add_u32 v112, v4, 10, v14
v_add_u32 v113, 7168, v112
v_add_u32 v114, 14336, v112
v_add_u32 v115, 21504, v112
s_mov_b32 s72, s14
s_mov_b32 s73, s15
s_mov_b32 s74, 0x1c0000
s_mov_b32 s75, 0x20000
s_mov_b32 s76, s8
s_mov_b32 s77, s9
s_mov_b32 s78, 0x80000
s_mov_b32 s79, 0x20000
s_lshl_b32 s64, s47, 7
s_mul_i32 s70, s40, 458752
s_add_u32 s70, s70, s64
s_lshl_b32 s71, s40, 17
s_add_u32 s71, s71, s64
s_mul_i32 s55, s40, 12288
s_add_u32 s3, s46, s47
s_add_u32 s64, s3, 0
s_and_b32 s64, s64, 3
s_mul_i32 s64, s64, 114688
s_add_u32 s12, s64, s70
s_add_u32 s64, s3, 1
s_and_b32 s64, s64, 3
s_mul_i32 s64, s64, 114688
s_add_u32 s13, s64, s70
s_add_u32 s64, s3, 2
s_and_b32 s64, s64, 3
s_mul_i32 s64, s64, 114688
s_add_u32 s14, s64, s70
s_add_u32 s64, s3, 3
s_and_b32 s64, s64, 3
s_mul_i32 s64, s64, 114688
s_add_u32 s15, s64, s70
v_lshl_add_u32 v14, v11, 2, v12
v_bfe_u32 v15, v14, 1, 2
v_lshl_add_u32 v14, v14, 7, v13
v_add_u32 v14, s55, v14
v_lshlrev_b32 v94, 3, v10
v_lshlrev_b32 v95, 4, v1
v_and_b32 v99, 0x1ff, v95
v_lshlrev_b32 v96, 4, v10
v_lshlrev_b32 v97, 3, v7
v_xor_b32 v16, 0, v15
v_lshl_add_u32 v4, v16, 5, v14
v_xor_b32 v16, 1, v15
v_lshl_add_u32 v5, v16, 5, v14
v_xor_b32 v16, 2, v15
v_lshl_add_u32 v6, v16, 5, v14
v_xor_b32 v16, 3, v15
v_lshl_add_u32 v7, v16, 5, v14
v_add_u32 v8, 49152, v4
v_add_u32 v9, 49152, v5
v_add_u32 v10, 49152, v6
v_add_u32 v11, 49152, v7
v_add_u32 v12, 98304, v4
v_add_u32 v13, 98304, v5
v_add_u32 v14, 98304, v6
v_add_u32 v15, 98304, v7
v_mov_b32 v28, 0x3f803f80
v_mov_b32 v29, 0x3f803f80
v_mov_b32 v30, 0x3f803f80
v_mov_b32 v31, 0x3f803f80
s_lshl_b32 s56, s43, 10
s_lshl_b32 s64, s41, 9
s_add_u32 s56, s56, s64
s_lshl_b32 s57, s44, 1
s_add_u32 s57, s57, s42
s_mul_i32 s57, s57, 7168
s_add_u32 s57, s57, 65536
s_lshr_b32 s64, s2, 3
s_lshl_b32 s64, s64, 2
s_add_u32 s64, s64, s40
v_min_u32 v98, 15, v1
v_lshlrev_b32 v98, 7, v98
s_lshl_b32 s65, s64, 12
v_add_u32 v26, s65, v98
s_mul_i32 s65, s64, 14336
v_add_u32 v98, s65, v98
s_waitcnt vmcnt(13)
v_lshlrev_b32 v40, 16, v32
v_and_b32 v41, 0xffff0000, v32
v_lshlrev_b32 v42, 16, v33
v_and_b32 v43, 0xffff0000, v33
v_lshlrev_b32 v44, 16, v34
v_and_b32 v45, 0xffff0000, v34
v_lshlrev_b32 v46, 16, v35
v_and_b32 v47, 0xffff0000, v35
v_lshlrev_b32 v48, 16, v36
v_and_b32 v49, 0xffff0000, v36
v_lshlrev_b32 v50, 16, v37
v_and_b32 v51, 0xffff0000, v37
v_lshlrev_b32 v52, 16, v38
v_and_b32 v53, 0xffff0000, v38
v_lshlrev_b32 v54, 16, v39
v_and_b32 v55, 0xffff0000, v39
v_pk_add_f32 v[18:19], v[40:41], v[42:43]
v_pk_add_f32 v[20:21], v[44:45], v[46:47]
v_pk_add_f32 v[22:23], v[48:49], v[50:51]
v_pk_add_f32 v[24:25], v[52:53], v[54:55]
v_pk_add_f32 v[18:19], v[18:19], v[20:21]
v_pk_add_f32 v[22:23], v[22:23], v[24:25]
v_pk_add_f32 v[18:19], v[18:19], v[22:23]
v_add_f32 v18, v18, v19
s_nop 1
v_add_f32_dpp v18, v18, v18 row_ror:8 row_mask:0xf bank_mask:0xf
s_nop 1
v_add_f32_dpp v18, v18, v18 row_ror:4 row_mask:0xf bank_mask:0xf
s_nop 1
v_add_f32_dpp v18, v18, v18 row_ror:2 row_mask:0xf bank_mask:0xf
s_nop 1
v_add_f32_dpp v18, v18, v18 row_ror:1 row_mask:0xf bank_mask:0xf
s_nop 1
v_mov_b32 v19, v18
s_nop 1
v_permlane16_swap_b32 v18, v19
s_nop 1
v_add_f32 v18, v18, v19
v_mul_f32 v20, 0xbb000000, v18
v_mov_b32 v21, v20
v_pk_add_f32 v[40:41], v[40:41], v[20:21]
v_pk_add_f32 v[42:43], v[42:43], v[20:21]
v_pk_add_f32 v[44:45], v[44:45], v[20:21]
v_pk_add_f32 v[46:47], v[46:47], v[20:21]
v_pk_add_f32 v[48:49], v[48:49], v[20:21]
v_pk_add_f32 v[50:51], v[50:51], v[20:21]
v_pk_add_f32 v[52:53], v[52:53], v[20:21]
v_pk_add_f32 v[54:55], v[54:55], v[20:21]
v_pk_mul_f32 v[22:23], v[40:41], v[40:41]
v_pk_mul_f32 v[24:25], v[42:43], v[42:43]
v_pk_fma_f32 v[22:23], v[44:45], v[44:45], v[22:23]
v_pk_fma_f32 v[24:25], v[46:47], v[46:47], v[24:25]
v_pk_fma_f32 v[22:23], v[48:49], v[48:49], v[22:23]
v_pk_fma_f32 v[24:25], v[50:51], v[50:51], v[24:25]
v_pk_fma_f32 v[22:23], v[52:53], v[52:53], v[22:23]
v_pk_fma_f32 v[24:25], v[54:55], v[54:55], v[24:25]
v_pk_add_f32 v[22:23], v[22:23], v[24:25]
v_add_f32 v22, v22, v23
s_nop 1
v_add_f32_dpp v22, v22, v22 row_ror:8 row_mask:0xf bank_mask:0xf
s_nop 1
v_add_f32_dpp v22, v22, v22 row_ror:4 row_mask:0xf bank_mask:0xf
s_nop 1
v_add_f32_dpp v22, v22, v22 row_ror:2 row_mask:0xf bank_mask:0xf
s_nop 1
v_add_f32_dpp v22, v22, v22 row_ror:1 row_mask:0xf bank_mask:0xf
s_nop 1
v_mov_b32 v23, v22
s_nop 1
v_permlane16_swap_b32 v22, v23
s_nop 1
v_add_f32 v22, v22, v23
v_mul_f32 v22, 0x3b000000, v22
v_cvt_pk_bf16_f32 v22, v22, v22
v_and_b32 v22, 0xffff0000, v22
v_add_f32 v22, 0x3727c5ac, v22
v_cvt_pk_bf16_f32 v22, v22, v22
v_and_b32 v22, 0xffff0000, v22
v_sqrt_f32 v22, v22
s_nop 0
v_cvt_pk_bf16_f32 v92, v20, v22
s_lshl_b32 s50, s48, 7
s_add_u32 s50, s50, s58
s_mul_i32 s51, s48, 229376
s_add_u32 s51, s51, s59
s_add_u32 s48, s48, 1
s_and_b32 s48, s48, 7
s_add_u32 m0, s53, 49152
s_nop 0
buffer_load_dwordx4 v100, s[16:19], s50 offen offset:0 lds
buffer_load_dwordx4 v101, s[16:19], s50 offen offset:1024 lds
buffer_load_dwordx4 v102, s[16:19], s50 offen offset:2048 lds
buffer_load_dwordx4 v103, s[16:19], s50 offen offset:3072 lds
s_add_u32 m0, s54, 49152
s_nop 0
buffer_load_dwordx4 v104, s[20:23], s51 offen offset:0 lds
buffer_load_dwordx4 v105, s[20:23], s51 offen offset:1024 lds
buffer_load_dwordx4 v106, s[20:23], s51 offen offset:2048 lds
buffer_load_dwordx4 v107, s[20:23], s51 offen offset:3072 lds
s_add_u32 m0, s54, 53248
s_nop 0
buffer_load_dwordx4 v108, s[20:23], s51 offen offset:0 lds
buffer_load_dwordx4 v109, s[20:23], s51 offen offset:1024 lds
buffer_load_dwordx4 v110, s[20:23], s51 offen offset:2048 lds
buffer_load_dwordx4 v111, s[20:23], s51 offen offset:3072 lds
s_lshl_b32 s64, s2, 2
s_add_u32 s64, s64, s40
s_mul_i32 s65, s64, 1792
s_lshl_b32 s64, s64, 9
v_min_u32 v16, 13, v1
v_lshlrev_b32 v16, 7, v16
v_and_b32 v17, 3, v1
v_lshlrev_b32 v17, 7, v17
buffer_load_dword v27, v16, s[72:75], s65 offen
buffer_load_dword v27, v17, s[76:79], s64 offen
s_waitcnt vmcnt(15)
s_barrier
ds_read_b64_tr_b16 a[16:17], v118 offset:0
ds_read_b64_tr_b16 a[18:19], v118 offset:2048
ds_read_b128 a[0:3], v116 offset:0
ds_read_b128 a[4:7], v116 offset:2048
ds_read_b128 a[8:11], v116 offset:4096
ds_read_b128 a[12:15], v116 offset:6144
ds_read_b64_tr_b16 a[20:21], v119 offset:0
ds_read_b64_tr_b16 a[22:23], v119 offset:2048
ds_read_b64_tr_b16 a[24:25], v120 offset:0
ds_read_b64_tr_b16 a[26:27], v120 offset:2048
ds_read_b64_tr_b16 a[28:29], v121 offset:0
ds_read_b64_tr_b16 a[30:31], v121 offset:2048
ds_read_b64_tr_b16 a[32:33], v122 offset:0
ds_read_b64_tr_b16 a[34:35], v122 offset:2048
ds_read_b64_tr_b16 a[36:37], v123 offset:0
ds_read_b64_tr_b16 a[38:39], v123 offset:2048
ds_read_b64_tr_b16 a[40:41], v124 offset:0
ds_read_b64_tr_b16 a[42:43], v124 offset:2048
s_waitcnt lgkmcnt(0)
v_mfma_f32_16x16x32_bf16 v[128:131], a[16:19], a[0:3], 0
ds_read_b64_tr_b16 a[60:61], v118 offset:16384
s_lshl_b32 s50, s48, 7
s_add_u32 s50, s50, s58
s_mul_i32 s51, s48, 229376
s_add_u32 s51, s51, s59
s_add_u32 s48, s48, 1
s_and_b32 s48, s48, 7
s_add_u32 m0, s53, 98304
v_mfma_f32_16x16x32_bf16 v[132:135], a[16:19], a[4:7], 0
ds_read_b64_tr_b16 a[62:63], v118 offset:18432
buffer_load_dwordx4 v100, s[16:19], s50 offen offset:0 lds
v_mfma_f32_16x16x32_bf16 v[136:139], a[16:19], a[8:11], 0
ds_read_b128 a[44:47], v117 offset:0
v_mfma_f32_16x16x32_bf16 v[140:143], a[16:19], a[12:15], 0
ds_read_b128 a[48:51], v117 offset:2048
buffer_load_dwordx4 v101, s[16:19], s50 offen offset:1024 lds
v_mfma_f32_16x16x32_bf16 v[144:147], a[20:23], a[0:3], 0
ds_read_b128 a[52:55], v117 offset:4096
v_mfma_f32_16x16x32_bf16 v[148:151], a[20:23], a[4:7], 0
ds_read_b128 a[56:59], v117 offset:6144
buffer_load_dwordx4 v102, s[16:19], s50 offen offset:2048 lds
v_mfma_f32_16x16x32_bf16 v[152:155], a[20:23], a[8:11], 0
ds_read_b64_tr_b16 a[64:65], v119 offset:16384
v_mfma_f32_16x16x32_bf16 v[156:159], a[20:23], a[12:15], 0
ds_read_b64_tr_b16 a[66:67], v119 offset:18432
buffer_load_dwordx4 v103, s[16:19], s50 offen offset:3072 lds
v_mfma_f32_16x16x32_bf16 v[160:163], a[24:27], a[0:3], 0
ds_read_b64_tr_b16 a[68:69], v120 offset:16384
s_add_u32 m0, s54, 98304
v_mfma_f32_16x16x32_bf16 v[164:167], a[24:27], a[4:7], 0
ds_read_b64_tr_b16 a[70:71], v120 offset:18432
buffer_load_dwordx4 v104, s[20:23], s51 offen offset:0 lds
v_mfma_f32_16x16x32_bf16 v[168:171], a[24:27], a[8:11], 0
ds_read_b64_tr_b16 a[72:73], v121 offset:16384
v_mfma_f32_16x16x32_bf16 v[172:175], a[24:27], a[12:15], 0
ds_read_b64_tr_b16 a[74:75], v121 offset:18432
buffer_load_dwordx4 v105, s[20:23], s51 offen offset:1024 lds
v_mfma_f32_16x16x32_bf16 v[176:179], a[28:31], a[0:3], 0
ds_read_b64_tr_b16 a[76:77], v122 offset:16384
v_mfma_f32_16x16x32_bf16 v[180:183], a[28:31], a[4:7], 0
ds_read_b64_tr_b16 a[78:79], v122 offset:18432
buffer_load_dwordx4 v106, s[20:23], s51 offen offset:2048 lds
v_mfma_f32_16x16x32_bf16 v[184:187], a[28:31], a[8:11], 0
ds_read_b64_tr_b16 a[80:81], v123 offset:16384
v_mfma_f32_16x16x32_bf16 v[188:191], a[28:31], a[12:15], 0
ds_read_b64_tr_b16 a[82:83], v123 offset:18432
buffer_load_dwordx4 v107, s[20:23], s51 offen offset:3072 lds
v_mfma_f32_16x16x32_bf16 v[192:195], a[32:35], a[0:3], 0
ds_read_b64_tr_b16 a[84:85], v124 offset:16384
s_add_u32 m0, s54, 102400
v_mfma_f32_16x16x32_bf16 v[196:199], a[32:35], a[4:7], 0
ds_read_b64_tr_b16 a[86:87], v124 offset:18432
buffer_load_dwordx4 v108, s[20:23], s51 offen offset:0 lds
v_mfma_f32_16x16x32_bf16 v[200:203], a[32:35], a[8:11], 0
v_mfma_f32_16x16x32_bf16 v[204:207], a[32:35], a[12:15], 0
buffer_load_dwordx4 v109, s[20:23], s51 offen offset:1024 lds
v_mfma_f32_16x16x32_bf16 v[208:211], a[36:39], a[0:3], 0
v_mfma_f32_16x16x32_bf16 v[212:215], a[36:39], a[4:7], 0
buffer_load_dwordx4 v110, s[20:23], s51 offen offset:2048 lds
v_mfma_f32_16x16x32_bf16 v[216:219], a[36:39], a[8:11], 0
v_mfma_f32_16x16x32_bf16 v[220:223], a[36:39], a[12:15], 0
buffer_load_dwordx4 v111, s[20:23], s51 offen offset:3072 lds
v_mfma_f32_16x16x32_bf16 v[224:227], a[40:43], a[0:3], 0
v_mov_b32 v16, 0
v_mfma_f32_16x16x32_bf16 v[228:231], a[40:43], a[4:7], 0
buffer_load_dword v93, v16, s[28:31], 0 offen sc1
v_mfma_f32_16x16x32_bf16 v[232:235], a[40:43], a[8:11], 0
v_mfma_f32_16x16x32_bf16 v[236:239], a[40:43], a[12:15], 0
s_cmp_lt_u32 s43, 4
s_cbranch_scc0 L_csh0
s_cmp_eq_u32 s41, 0
s_cbranch_scc0 L_csh0h
v_mfma_f32_16x16x32_bf16 v[64:67], v[28:31], a[16:19], 0
v_mfma_f32_16x16x32_bf16 v[68:71], v[28:31], a[20:23], 0
v_mfma_f32_16x16x32_bf16 v[72:75], v[28:31], a[24:27], 0
v_mfma_f32_16x16x32_bf16 v[76:79], v[28:31], a[28:31], 0
s_branch L_csh0
L_csh0h:
v_mfma_f32_16x16x32_bf16 v[64:67], v[28:31], a[32:35], 0
v_mfma_f32_16x16x32_bf16 v[68:71], v[28:31], a[36:39], 0
v_mfma_f32_16x16x32_bf16 v[72:75], v[28:31], a[40:43], 0
L_csh0:
s_waitcnt vmcnt(15) lgkmcnt(0)
s_barrier
v_mfma_f32_16x16x32_bf16 v[128:131], a[60:63], a[44:47], v[128:131]
ds_read_b64_tr_b16 a[16:17], v127 offset:0
v_mfma_f32_16x16x32_bf16 v[132:135], a[60:63], a[48:51], v[132:135]
ds_read_b64_tr_b16 a[18:19], v127 offset:2048
v_mfma_f32_16x16x32_bf16 v[136:139], a[60:63], a[52:55], v[136:139]
ds_read_b128 a[0:3], v125 offset:0
v_mfma_f32_16x16x32_bf16 v[140:143], a[60:63], a[56:59], v[140:143]
ds_read_b128 a[4:7], v125 offset:2048
v_mfma_f32_16x16x32_bf16 v[144:147], a[64:67], a[44:47], v[144:147]
ds_read_b128 a[8:11], v125 offset:4096
v_mfma_f32_16x16x32_bf16 v[148:151], a[64:67], a[48:51], v[148:151]
ds_read_b128 a[12:15], v125 offset:6144
v_mfma_f32_16x16x32_bf16 v[152:155], a[64:67], a[52:55], v[152:155]
ds_read_b64_tr_b16 a[20:21], v240 offset:0
s_lshl_b32 s50, s48, 7
v_mfma_f32_16x16x32_bf16 v[156:159], a[64:67], a[56:59], v[156:159]
ds_read_b64_tr_b16 a[22:23], v240 offset:2048
s_add_u32 s50, s50, s58
v_mfma_f32_16x16x32_bf16 v[160:163], a[68:71], a[44:47], v[160:163]
ds_read_b64_tr_b16 a[24:25], v241 offset:0
s_mul_i32 s51, s48, 229376
v_mfma_f32_16x16x32_bf16 v[164:167], a[68:71], a[48:51], v[164:167]
ds_read_b64_tr_b16 a[26:27], v241 offset:2048
s_add_u32 s51, s51, s59
v_mfma_f32_16x16x32_bf16 v[168:171], a[68:71], a[52:55], v[168:171]
ds_read_b64_tr_b16 a[28:29], v242 offset:0
s_add_u32 s48, s48, 1
v_mfma_f32_16x16x32_bf16 v[172:175], a[68:71], a[56:59], v[172:175]
ds_read_b64_tr_b16 a[30:31], v242 offset:2048
s_and_b32 s48, s48, 7
v_mfma_f32_16x16x32_bf16 v[176:179], a[72:75], a[44:47], v[176:179]
ds_read_b64_tr_b16 a[32:33], v243 offset:0
s_add_u32 m0, s53, 0
v_mfma_f32_16x16x32_bf16 v[180:183], a[72:75], a[48:51], v[180:183]
ds_read_b64_tr_b16 a[34:35], v243 offset:2048
buffer_load_dwordx4 v100, s[16:19], s50 offen offset:0 lds
v_mfma_f32_16x16x32_bf16 v[184:187], a[72:75], a[52:55], v[184:187]
ds_read_b64_tr_b16 a[36:37], v244 offset:0
v_mfma_f32_16x16x32_bf16 v[188:191], a[72:75], a[56:59], v[188:191]
ds_read_b64_tr_b16 a[38:39], v244 offset:2048
buffer_load_dwordx4 v101, s[16:19], s50 offen offset:1024 lds
v_mfma_f32_16x16x32_bf16 v[192:195], a[76:79], a[44:47], v[192:195]
ds_read_b64_tr_b16 a[40:41], v245 offset:0
v_mfma_f32_16x16x32_bf16 v[196:199], a[76:79], a[48:51], v[196:199]
ds_read_b64_tr_b16 a[42:43], v245 offset:2048
buffer_load_dwordx4 v102, s[16:19], s50 offen offset:2048 lds
v_mfma_f32_16x16x32_bf16 v[200:203], a[76:79], a[52:55], v[200:203]
v_mfma_f32_16x16x32_bf16 v[204:207], a[76:79], a[56:59], v[204:207]
buffer_load_dwordx4 v103, s[16:19], s50 offen offset:3072 lds
v_mfma_f32_16x16x32_bf16 v[208:211], a[80:83], a[44:47], v[208:211]
s_add_u32 m0, s54, 0
v_mfma_f32_16x16x32_bf16 v[212:215], a[80:83], a[48:51], v[212:215]
buffer_load_dwordx4 v104, s[20:23], s51 offen offset:0 lds
v_mfma_f32_16x16x32_bf16 v[216:219], a[80:83], a[52:55], v[216:219]
v_mfma_f32_16x16x32_bf16 v[220:223], a[80:83], a[56:59], v[220:223]
buffer_load_dwordx4 v105, s[20:23], s51 offen offset:1024 lds
v_mfma_f32_16x16x32_bf16 v[224:227], a[84:87], a[44:47], v[224:227]
v_mfma_f32_16x16x32_bf16 v[228:231], a[84:87], a[48:51], v[228:231]
v_mfma_f32_16x16x32_bf16 v[232:235], a[84:87], a[52:55], v[232:235]
v_mfma_f32_16x16x32_bf16 v[236:239], a[84:87], a[56:59], v[236:239]
s_cmp_lt_u32 s43, 4
s_cbranch_scc0 L_csh1
s_cmp_eq_u32 s41, 0
s_cbranch_scc0 L_csh1h
v_mfma_f32_16x16x32_bf16 v[64:67], v[28:31], a[60:63], v[64:67]
v_mfma_f32_16x16x32_bf16 v[68:71], v[28:31], a[64:67], v[68:71]
v_mfma_f32_16x16x32_bf16 v[72:75], v[28:31], a[68:71], v[72:75]
v_mfma_f32_16x16x32_bf16 v[76:79], v[28:31], a[72:75], v[76:79]
s_branch L_csh1
L_csh1h:
v_mfma_f32_16x16x32_bf16 v[64:67], v[28:31], a[76:79], v[64:67]
v_mfma_f32_16x16x32_bf16 v[68:71], v[28:31], a[80:83], v[68:71]
v_mfma_f32_16x16x32_bf16 v[72:75], v[28:31], a[84:87], v[72:75]
L_csh1:
s_waitcnt lgkmcnt(0)
v_mfma_f32_16x16x32_bf16 v[128:131], a[16:19], a[0:3], v[128:131]
ds_read_b64_tr_b16 a[60:61], v127 offset:16384
v_mfma_f32_16x16x32_bf16 v[132:135], a[16:19], a[4:7], v[132:135]
ds_read_b64_tr_b16 a[62:63], v127 offset:18432
v_mfma_f32_16x16x32_bf16 v[136:139], a[16:19], a[8:11], v[136:139]
ds_read_b128 a[44:47], v126 offset:0
v_mfma_f32_16x16x32_bf16 v[140:143], a[16:19], a[12:15], v[140:143]
ds_read_b128 a[48:51], v126 offset:2048
v_mfma_f32_16x16x32_bf16 v[144:147], a[20:23], a[0:3], v[144:147]
ds_read_b128 a[52:55], v126 offset:4096
v_mfma_f32_16x16x32_bf16 v[148:151], a[20:23], a[4:7], v[148:151]
ds_read_b128 a[56:59], v126 offset:6144
v_mfma_f32_16x16x32_bf16 v[152:155], a[20:23], a[8:11], v[152:155]
ds_read_b64_tr_b16 a[64:65], v240 offset:16384
v_mfma_f32_16x16x32_bf16 v[156:159], a[20:23], a[12:15], v[156:159]
ds_read_b64_tr_b16 a[66:67], v240 offset:18432
v_mfma_f32_16x16x32_bf16 v[160:163], a[24:27], a[0:3], v[160:163]
ds_read_b64_tr_b16 a[68:69], v241 offset:16384
v_mfma_f32_16x16x32_bf16 v[164:167], a[24:27], a[4:7], v[164:167]
ds_read_b64_tr_b16 a[70:71], v241 offset:18432
v_mfma_f32_16x16x32_bf16 v[168:171], a[24:27], a[8:11], v[168:171]
ds_read_b64_tr_b16 a[72:73], v242 offset:16384
v_mfma_f32_16x16x32_bf16 v[172:175], a[24:27], a[12:15], v[172:175]
ds_read_b64_tr_b16 a[74:75], v242 offset:18432
v_mfma_f32_16x16x32_bf16 v[176:179], a[28:31], a[0:3], v[176:179]
ds_read_b64_tr_b16 a[76:77], v243 offset:16384
v_mfma_f32_16x16x32_bf16 v[180:183], a[28:31], a[4:7], v[180:183]
ds_read_b64_tr_b16 a[78:79], v243 offset:18432
buffer_load_dwordx4 v106, s[20:23], s51 offen offset:2048 lds
v_mfma_f32_16x16x32_bf16 v[184:187], a[28:31], a[8:11], v[184:187]
ds_read_b64_tr_b16 a[80:81], v244 offset:16384
v_mfma_f32_16x16x32_bf16 v[188:191], a[28:31], a[12:15], v[188:191]
ds_read_b64_tr_b16 a[82:83], v244 offset:18432
buffer_load_dwordx4 v107, s[20:23], s51 offen offset:3072 lds
v_mfma_f32_16x16x32_bf16 v[192:195], a[32:35], a[0:3], v[192:195]
ds_read_b64_tr_b16 a[84:85], v245 offset:16384
s_add_u32 m0, s54, 4096
v_mfma_f32_16x16x32_bf16 v[196:199], a[32:35], a[4:7], v[196:199]
ds_read_b64_tr_b16 a[86:87], v245 offset:18432
buffer_load_dwordx4 v108, s[20:23], s51 offen offset:0 lds
v_mfma_f32_16x16x32_bf16 v[200:203], a[32:35], a[8:11], v[200:203]
v_mfma_f32_16x16x32_bf16 v[204:207], a[32:35], a[12:15], v[204:207]
buffer_load_dwordx4 v109, s[20:23], s51 offen offset:1024 lds
v_mfma_f32_16x16x32_bf16 v[208:211], a[36:39], a[0:3], v[208:211]
v_mfma_f32_16x16x32_bf16 v[212:215], a[36:39], a[4:7], v[212:215]
buffer_load_dwordx4 v110, s[20:23], s51 offen offset:2048 lds
v_mfma_f32_16x16x32_bf16 v[216:219], a[36:39], a[8:11], v[216:219]
v_mfma_f32_16x16x32_bf16 v[220:223], a[36:39], a[12:15], v[220:223]
buffer_load_dwordx4 v111, s[20:23], s51 offen offset:3072 lds
v_mfma_f32_16x16x32_bf16 v[224:227], a[40:43], a[0:3], v[224:227]
v_mfma_f32_16x16x32_bf16 v[228:231], a[40:43], a[4:7], v[228:231]
v_mfma_f32_16x16x32_bf16 v[232:235], a[40:43], a[8:11], v[232:235]
v_mfma_f32_16x16x32_bf16 v[236:239], a[40:43], a[12:15], v[236:239]
s_cmp_lt_u32 s43, 4
s_cbranch_scc0 L_csh2
s_cmp_eq_u32 s41, 0
s_cbranch_scc0 L_csh2h
v_mfma_f32_16x16x32_bf16 v[64:67], v[28:31], a[16:19], v[64:67]
v_mfma_f32_16x16x32_bf16 v[68:71], v[28:31], a[20:23], v[68:71]
v_mfma_f32_16x16x32_bf16 v[72:75], v[28:31], a[24:27], v[72:75]
v_mfma_f32_16x16x32_bf16 v[76:79], v[28:31], a[28:31], v[76:79]
s_branch L_csh2
L_csh2h:
v_mfma_f32_16x16x32_bf16 v[64:67], v[28:31], a[32:35], v[64:67]
v_mfma_f32_16x16x32_bf16 v[68:71], v[28:31], a[36:39], v[68:71]
v_mfma_f32_16x16x32_bf16 v[72:75], v[28:31], a[40:43], v[72:75]
L_csh2:
s_waitcnt vmcnt(12) lgkmcnt(0)
s_barrier
v_readfirstlane_b32 s60, v93
s_mov_b32 s61, 0
s_cmp_eq_u32 s60, 0
s_cbranch_scc1 L_nspinh
L_nbackh:
v_mfma_f32_16x16x32_bf16 v[128:131], a[60:63], a[44:47], v[128:131]
ds_read_b64_tr_b16 a[16:17], v248 offset:0
v_mfma_f32_16x16x32_bf16 v[132:135], a[60:63], a[48:51], v[132:135]
ds_read_b64_tr_b16 a[18:19], v248 offset:2048
v_mfma_f32_16x16x32_bf16 v[136:139], a[60:63], a[52:55], v[136:139]
ds_read_b128 a[0:3], v246 offset:0
v_mfma_f32_16x16x32_bf16 v[140:143], a[60:63], a[56:59], v[140:143]
ds_read_b128 a[4:7], v246 offset:2048
v_mfma_f32_16x16x32_bf16 v[144:147], a[64:67], a[44:47], v[144:147]
ds_read_b128 a[8:11], v246 offset:4096
v_mfma_f32_16x16x32_bf16 v[148:151], a[64:67], a[48:51], v[148:151]
ds_read_b128 a[12:15], v246 offset:6144
v_mfma_f32_16x16x32_bf16 v[152:155], a[64:67], a[52:55], v[152:155]
ds_read_b64_tr_b16 a[20:21], v249 offset:0
s_lshl_b32 s50, s48, 7
v_mfma_f32_16x16x32_bf16 v[156:159], a[64:67], a[56:59], v[156:159]
ds_read_b64_tr_b16 a[22:23], v249 offset:2048
s_add_u32 s50, s50, s58
v_mfma_f32_16x16x32_bf16 v[160:163], a[68:71], a[44:47], v[160:163]
ds_read_b64_tr_b16 a[24:25], v250 offset:0
s_mul_i32 s51, s48, 229376
v_mfma_f32_16x16x32_bf16 v[164:167], a[68:71], a[48:51], v[164:167]
ds_read_b64_tr_b16 a[26:27], v250 offset:2048
s_add_u32 s51, s51, s59
v_mfma_f32_16x16x32_bf16 v[168:171], a[68:71], a[52:55], v[168:171]
ds_read_b64_tr_b16 a[28:29], v251 offset:0
s_add_u32 s48, s48, 1
v_mfma_f32_16x16x32_bf16 v[172:175], a[68:71], a[56:59], v[172:175]
ds_read_b64_tr_b16 a[30:31], v251 offset:2048
s_and_b32 s48, s48, 7
v_mfma_f32_16x16x32_bf16 v[176:179], a[72:75], a[44:47], v[176:179]
ds_read_b64_tr_b16 a[32:33], v252 offset:0
s_add_u32 m0, s53, 49152
v_mfma_f32_16x16x32_bf16 v[180:183], a[72:75], a[48:51], v[180:183]
ds_read_b64_tr_b16 a[34:35], v252 offset:2048
buffer_load_dwordx4 v100, s[16:19], s50 offen offset:0 lds
v_mfma_f32_16x16x32_bf16 v[184:187], a[72:75], a[52:55], v[184:187]
ds_read_b64_tr_b16 a[36:37], v253 offset:0
v_mfma_f32_16x16x32_bf16 v[188:191], a[72:75], a[56:59], v[188:191]
ds_read_b64_tr_b16 a[38:39], v253 offset:2048
buffer_load_dwordx4 v101, s[16:19], s50 offen offset:1024 lds
v_mfma_f32_16x16x32_bf16 v[192:195], a[76:79], a[44:47], v[192:195]
ds_read_b64_tr_b16 a[40:41], v254 offset:0
v_mfma_f32_16x16x32_bf16 v[196:199], a[76:79], a[48:51], v[196:199]
ds_read_b64_tr_b16 a[42:43], v254 offset:2048
buffer_load_dwordx4 v102, s[16:19], s50 offen offset:2048 lds
v_mfma_f32_16x16x32_bf16 v[200:203], a[76:79], a[52:55], v[200:203]
v_mfma_f32_16x16x32_bf16 v[204:207], a[76:79], a[56:59], v[204:207]
buffer_load_dwordx4 v103, s[16:19], s50 offen offset:3072 lds
v_mfma_f32_16x16x32_bf16 v[208:211], a[80:83], a[44:47], v[208:211]
s_add_u32 m0, s54, 49152
v_mfma_f32_16x16x32_bf16 v[212:215], a[80:83], a[48:51], v[212:215]
buffer_load_dwordx4 v104, s[20:23], s51 offen offset:0 lds
v_mfma_f32_16x16x32_bf16 v[216:219], a[80:83], a[52:55], v[216:219]
v_mfma_f32_16x16x32_bf16 v[220:223], a[80:83], a[56:59], v[220:223]
buffer_load_dwordx4 v105, s[20:23], s51 offen offset:1024 lds
v_mfma_f32_16x16x32_bf16 v[224:227], a[84:87], a[44:47], v[224:227]
v_mfma_f32_16x16x32_bf16 v[228:231], a[84:87], a[48:51], v[228:231]
v_mfma_f32_16x16x32_bf16 v[232:235], a[84:87], a[52:55], v[232:235]
v_mfma_f32_16x16x32_bf16 v[236:239], a[84:87], a[56:59], v[236:239]
s_cmp_lt_u32 s43, 4
s_cbranch_scc0 L_csh3
s_cmp_eq_u32 s41, 0
s_cbranch_scc0 L_csh3h
v_mfma_f32_16x16x32_bf16 v[64:67], v[28:31], a[60:63], v[64:67]
v_mfma_f32_16x16x32_bf16 v[68:71], v[28:31], a[64:67], v[68:71]
v_mfma_f32_16x16x32_bf16 v[72:75], v[28:31], a[68:71], v[72:75]
v_mfma_f32_16x16x32_bf16 v[76:79], v[28:31], a[72:75], v[76:79]
s_branch L_csh3
L_csh3h:
v_mfma_f32_16x16x32_bf16 v[64:67], v[28:31], a[76:79], v[64:67]
v_mfma_f32_16x16x32_bf16 v[68:71], v[28:31], a[80:83], v[68:71]
v_mfma_f32_16x16x32_bf16 v[72:75], v[28:31], a[84:87], v[72:75]
L_csh3:
s_waitcnt lgkmcnt(0)
v_mfma_f32_16x16x32_bf16 v[128:131], a[16:19], a[0:3], v[128:131]
ds_read_b64_tr_b16 a[60:61], v248 offset:16384
v_mfma_f32_16x16x32_bf16 v[132:135], a[16:19], a[4:7], v[132:135]
ds_read_b64_tr_b16 a[62:63], v248 offset:18432
v_mfma_f32_16x16x32_bf16 v[136:139], a[16:19], a[8:11], v[136:139]
ds_read_b128 a[44:47], v247 offset:0
v_mfma_f32_16x16x32_bf16 v[140:143], a[16:19], a[12:15], v[140:143]
ds_read_b128 a[48:51], v247 offset:2048
v_mfma_f32_16x16x32_bf16 v[144:147], a[20:23], a[0:3], v[144:147]
ds_read_b128 a[52:55], v247 offset:4096
v_mfma_f32_16x16x32_bf16 v[148:151], a[20:23], a[4:7], v[148:151]
ds_read_b128 a[56:59], v247 offset:6144
v_mfma_f32_16x16x32_bf16 v[152:155], a[20:23], a[8:11], v[152:155]
ds_read_b64_tr_b16 a[64:65], v249 offset:16384
v_mfma_f32_16x16x32_bf16 v[156:159], a[20:23], a[12:15], v[156:159]
ds_read_b64_tr_b16 a[66:67], v249 offset:18432
v_mfma_f32_16x16x32_bf16 v[160:163], a[24:27], a[0:3], v[160:163]
ds_read_b64_tr_b16 a[68:69], v250 offset:16384
v_mfma_f32_16x16x32_bf16 v[164:167], a[24:27], a[4:7], v[164:167]
ds_read_b64_tr_b16 a[70:71], v250 offset:18432
s_lshl_b32 s63, s68, 3
s_mov_b32 exec_lo, 1
s_mov_b32 exec_hi, 1
buffer_store_dwordx2 v[92:93], v97, s[24:27], s63 offen sc1
s_mov_b64 exec, -1
v_mfma_f32_16x16x32_bf16 v[168:171], a[24:27], a[8:11], v[168:171]
ds_read_b64_tr_b16 a[72:73], v251 offset:16384
v_mfma_f32_16x16x32_bf16 v[172:175], a[24:27], a[12:15], v[172:175]
ds_read_b64_tr_b16 a[74:75], v251 offset:18432
v_mfma_f32_16x16x32_bf16 v[176:179], a[28:31], a[0:3], v[176:179]
ds_read_b64_tr_b16 a[76:77], v252 offset:16384
v_mfma_f32_16x16x32_bf16 v[180:183], a[28:31], a[4:7], v[180:183]
ds_read_b64_tr_b16 a[78:79], v252 offset:18432
buffer_load_dwordx4 v106, s[20:23], s51 offen offset:2048 lds
v_mfma_f32_16x16x32_bf16 v[184:187], a[28:31], a[8:11], v[184:187]
ds_read_b64_tr_b16 a[80:81], v253 offset:16384
v_mfma_f32_16x16x32_bf16 v[188:191], a[28:31], a[12:15], v[188:191]
ds_read_b64_tr_b16 a[82:83], v253 offset:18432
buffer_load_dwordx4 v107, s[20:23], s51 offen offset:3072 lds
v_mfma_f32_16x16x32_bf16 v[192:195], a[32:35], a[0:3], v[192:195]
ds_read_b64_tr_b16 a[84:85], v254 offset:16384
s_add_u32 m0, s54, 53248
v_mfma_f32_16x16x32_bf16 v[196:199], a[32:35], a[4:7], v[196:199]
ds_read_b64_tr_b16 a[86:87], v254 offset:18432
buffer_load_dwordx4 v108, s[20:23], s51 offen offset:0 lds
v_mfma_f32_16x16x32_bf16 v[200:203], a[32:35], a[8:11], v[200:203]
v_mfma_f32_16x16x32_bf16 v[204:207], a[32:35], a[12:15], v[204:207]
buffer_load_dwordx4 v109, s[20:23], s51 offen offset:1024 lds
v_mfma_f32_16x16x32_bf16 v[208:211], a[36:39], a[0:3], v[208:211]
v_mfma_f32_16x16x32_bf16 v[212:215], a[36:39], a[4:7], v[212:215]
buffer_load_dwordx4 v110, s[20:23], s51 offen offset:2048 lds
v_mfma_f32_16x16x32_bf16 v[216:219], a[36:39], a[8:11], v[216:219]
v_mfma_f32_16x16x32_bf16 v[220:223], a[36:39], a[12:15], v[220:223]
buffer_load_dwordx4 v111, s[20:23], s51 offen offset:3072 lds
v_mfma_f32_16x16x32_bf16 v[224:227], a[40:43], a[0:3], v[224:227]
v_mfma_f32_16x16x32_bf16 v[228:231], a[40:43], a[4:7], v[228:231]
v_mfma_f32_16x16x32_bf16 v[232:235], a[40:43], a[8:11], v[232:235]
v_mfma_f32_16x16x32_bf16 v[236:239], a[40:43], a[12:15], v[236:239]
s_waitcnt vmcnt(13) lgkmcnt(0)
s_barrier
v_mfma_f32_16x16x32_bf16 v[128:131], a[60:63], a[44:47], v[128:131]
ds_read_b64_tr_b16 a[16:17], v118 offset:0
v_cvt_pk_bf16_f32 v65, v64, v64
v_mfma_f32_16x16x32_bf16 v[132:135], a[60:63], a[48:51], v[132:135]
ds_read_b64_tr_b16 a[18:19], v118 offset:2048
v_and_b32 v65, 0xffff0000, v65
v_mfma_f32_16x16x32_bf16 v[136:139], a[60:63], a[52:55], v[136:139]
ds_read_b128 a[0:3], v116 offset:0
v_sub_f32 v65, v64, v65
v_mfma_f32_16x16x32_bf16 v[140:143], a[60:63], a[56:59], v[140:143]
ds_read_b128 a[4:7], v116 offset:2048
v_cvt_pk_bf16_f32 v64, v64, v65
v_mfma_f32_16x16x32_bf16 v[144:147], a[64:67], a[44:47], v[144:147]
ds_read_b128 a[8:11], v116 offset:4096
v_mov_b32 v65, v93
v_mfma_f32_16x16x32_bf16 v[148:151], a[64:67], a[48:51], v[148:151]
ds_read_b128 a[12:15], v116 offset:6144
v_mov_b32 v66, 0
v_mfma_f32_16x16x32_bf16 v[152:155], a[64:67], a[52:55], v[152:155]
ds_read_b64_tr_b16 a[20:21], v119 offset:0
s_lshl_b32 s50, s48, 7
v_mov_b32 v67, v93
v_mfma_f32_16x16x32_bf16 v[156:159], a[64:67], a[56:59], v[156:159]
ds_read_b64_tr_b16 a[22:23], v119 offset:2048
s_add_u32 s50, s50, s58
v_cvt_pk_bf16_f32 v69, v68, v68
v_mfma_f32_16x16x32_bf16 v[160:163], a[68:71], a[44:47], v[160:163]
ds_read_b64_tr_b16 a[24:25], v120 offset:0
s_mul_i32 s51, s48, 229376
v_and_b32 v69, 0xffff0000, v69
v_mfma_f32_16x16x32_bf16 v[164:167], a[68:71], a[48:51], v[164:167]
ds_read_b64_tr_b16 a[26:27], v120 offset:2048
s_add_u32 s51, s51, s59
v_sub_f32 v69, v68, v69
v_mfma_f32_16x16x32_bf16 v[168:171], a[68:71], a[52:55], v[168:171]
ds_read_b64_tr_b16 a[28:29], v121 offset:0
s_add_u32 s48, s48, 1
v_cvt_pk_bf16_f32 v68, v68, v69
v_mfma_f32_16x16x32_bf16 v[172:175], a[68:71], a[56:59], v[172:175]
ds_read_b64_tr_b16 a[30:31], v121 offset:2048
s_and_b32 s48, s48, 7
v_mov_b32 v69, v93
v_mfma_f32_16x16x32_bf16 v[176:179], a[72:75], a[44:47], v[176:179]
ds_read_b64_tr_b16 a[32:33], v122 offset:0
s_add_u32 m0, s53, 98304
v_mov_b32 v70, 0
v_mfma_f32_16x16x32_bf16 v[180:183], a[72:75], a[48:51], v[180:183]
ds_read_b64_tr_b16 a[34:35], v122 offset:2048
buffer_load_dwordx4 v100, s[16:19], s50 offen offset:0 lds
v_mov_b32 v71, v93
v_mfma_f32_16x16x32_bf16 v[184:187], a[72:75], a[52:55], v[184:187]
ds_read_b64_tr_b16 a[36:37], v123 offset:0
v_cvt_pk_bf16_f32 v73, v72, v72
v_mfma_f32_16x16x32_bf16 v[188:191], a[72:75], a[56:59], v[188:191]
ds_read_b64_tr_b16 a[38:39], v123 offset:2048
buffer_load_dwordx4 v101, s[16:19], s50 offen offset:1024 lds
v_and_b32 v73, 0xffff0000, v73
v_mfma_f32_16x16x32_bf16 v[192:195], a[76:79], a[44:47], v[192:195]
ds_read_b64_tr_b16 a[40:41], v124 offset:0
v_sub_f32 v73, v72, v73
v_mfma_f32_16x16x32_bf16 v[196:199], a[76:79], a[48:51], v[196:199]
ds_read_b64_tr_b16 a[42:43], v124 offset:2048
buffer_load_dwordx4 v102, s[16:19], s50 offen offset:2048 lds
v_cvt_pk_bf16_f32 v72, v72, v73
v_mfma_f32_16x16x32_bf16 v[200:203], a[76:79], a[52:55], v[200:203]
v_mov_b32 v73, v93
v_mfma_f32_16x16x32_bf16 v[204:207], a[76:79], a[56:59], v[204:207]
buffer_load_dwordx4 v103, s[16:19], s50 offen offset:3072 lds
v_mov_b32 v74, 0
v_mfma_f32_16x16x32_bf16 v[208:211], a[80:83], a[44:47], v[208:211]
s_add_u32 m0, s54, 98304
v_mov_b32 v75, v93
v_mfma_f32_16x16x32_bf16 v[212:215], a[80:83], a[48:51], v[212:215]
buffer_load_dwordx4 v104, s[20:23], s51 offen offset:0 lds
v_cvt_pk_bf16_f32 v77, v76, v76
v_mfma_f32_16x16x32_bf16 v[216:219], a[80:83], a[52:55], v[216:219]
v_and_b32 v77, 0xffff0000, v77
v_mfma_f32_16x16x32_bf16 v[220:223], a[80:83], a[56:59], v[220:223]
buffer_load_dwordx4 v105, s[20:23], s51 offen offset:1024 lds
v_sub_f32 v77, v76, v77
v_mfma_f32_16x16x32_bf16 v[224:227], a[84:87], a[44:47], v[224:227]
v_cvt_pk_bf16_f32 v76, v76, v77
v_mfma_f32_16x16x32_bf16 v[228:231], a[84:87], a[48:51], v[228:231]
v_mov_b32 v77, v93
v_mfma_f32_16x16x32_bf16 v[232:235], a[84:87], a[52:55], v[232:235]
v_mov_b32 v78, 0
v_mfma_f32_16x16x32_bf16 v[236:239], a[84:87], a[56:59], v[236:239]
v_mov_b32 v79, v93
s_waitcnt lgkmcnt(0)
v_mfma_f32_16x16x32_bf16 v[128:131], a[16:19], a[0:3], v[128:131]
ds_read_b64_tr_b16 a[60:61], v118 offset:16384
s_lshl_b32 s52, s49, 8
v_mfma_f32_16x16x32_bf16 v[132:135], a[16:19], a[4:7], v[132:135]
ds_read_b64_tr_b16 a[62:63], v118 offset:18432
s_add_u32 s52, s52, s57
v_mfma_f32_16x16x32_bf16 v[136:139], a[16:19], a[8:11], v[136:139]
ds_read_b128 a[44:47], v117 offset:0
s_mul_i32 s62, s41, 4096
v_mfma_f32_16x16x32_bf16 v[140:143], a[16:19], a[12:15], v[140:143]
ds_read_b128 a[48:51], v117 offset:2048
s_add_u32 s52, s52, s62
v_mfma_f32_16x16x32_bf16 v[144:147], a[20:23], a[0:3], v[144:147]
ds_read_b128 a[52:55], v117 offset:4096
v_mfma_f32_16x16x32_bf16 v[148:151], a[20:23], a[4:7], v[148:151]
ds_read_b128 a[56:59], v117 offset:6144
v_mfma_f32_16x16x32_bf16 v[152:155], a[20:23], a[8:11], v[152:155]
ds_read_b64_tr_b16 a[64:65], v119 offset:16384
v_mfma_f32_16x16x32_bf16 v[156:159], a[20:23], a[12:15], v[156:159]
ds_read_b64_tr_b16 a[66:67], v119 offset:18432
v_mfma_f32_16x16x32_bf16 v[160:163], a[24:27], a[0:3], v[160:163]
ds_read_b64_tr_b16 a[68:69], v120 offset:16384
s_cmp_lt_u32 s43, 4
s_cbranch_scc0 L_csth
s_mov_b64 exec, 0xffff
buffer_store_dwordx4 v[64:67], v96, s[24:27], s52 offen offset:0 sc1
buffer_store_dwordx4 v[68:71], v96, s[24:27], s52 offen offset:1024 sc1
buffer_store_dwordx4 v[72:75], v96, s[24:27], s52 offen offset:2048 sc1
s_cmp_eq_u32 s41, 0
s_cselect_b32 exec_lo, 0xffff, 0
buffer_store_dwordx4 v[76:79], v96, s[24:27], s52 offen offset:3072 sc1
s_mov_b64 exec, -1
L_csth:
v_mfma_f32_16x16x32_bf16 v[164:167], a[24:27], a[4:7], v[164:167]
ds_read_b64_tr_b16 a[70:71], v120 offset:18432
v_mfma_f32_16x16x32_bf16 v[168:171], a[24:27], a[8:11], v[168:171]
ds_read_b64_tr_b16 a[72:73], v121 offset:16384
v_mfma_f32_16x16x32_bf16 v[172:175], a[24:27], a[12:15], v[172:175]
ds_read_b64_tr_b16 a[74:75], v121 offset:18432
v_mfma_f32_16x16x32_bf16 v[176:179], a[28:31], a[0:3], v[176:179]
ds_read_b64_tr_b16 a[76:77], v122 offset:16384
v_mfma_f32_16x16x32_bf16 v[180:183], a[28:31], a[4:7], v[180:183]
ds_read_b64_tr_b16 a[78:79], v122 offset:18432
buffer_load_dwordx4 v106, s[20:23], s51 offen offset:2048 lds
v_mfma_f32_16x16x32_bf16 v[184:187], a[28:31], a[8:11], v[184:187]
ds_read_b64_tr_b16 a[80:81], v123 offset:16384
v_mfma_f32_16x16x32_bf16 v[188:191], a[28:31], a[12:15], v[188:191]
ds_read_b64_tr_b16 a[82:83], v123 offset:18432
buffer_load_dwordx4 v107, s[20:23], s51 offen offset:3072 lds
v_mfma_f32_16x16x32_bf16 v[192:195], a[32:35], a[0:3], v[192:195]
ds_read_b64_tr_b16 a[84:85], v124 offset:16384
s_add_u32 m0, s54, 102400
v_mfma_f32_16x16x32_bf16 v[196:199], a[32:35], a[4:7], v[196:199]
ds_read_b64_tr_b16 a[86:87], v124 offset:18432
buffer_load_dwordx4 v108, s[20:23], s51 offen offset:0 lds
v_mfma_f32_16x16x32_bf16 v[200:203], a[32:35], a[8:11], v[200:203]
v_mfma_f32_16x16x32_bf16 v[204:207], a[32:35], a[12:15], v[204:207]
buffer_load_dwordx4 v109, s[20:23], s51 offen offset:1024 lds
v_mfma_f32_16x16x32_bf16 v[208:211], a[36:39], a[0:3], v[208:211]
v_mfma_f32_16x16x32_bf16 v[212:215], a[36:39], a[4:7], v[212:215]
buffer_load_dwordx4 v110, s[20:23], s51 offen offset:2048 lds
v_mfma_f32_16x16x32_bf16 v[216:219], a[36:39], a[8:11], v[216:219]
v_mfma_f32_16x16x32_bf16 v[220:223], a[36:39], a[12:15], v[220:223]
buffer_load_dwordx4 v111, s[20:23], s51 offen offset:3072 lds
v_mfma_f32_16x16x32_bf16 v[224:227], a[40:43], a[0:3], v[224:227]
v_mfma_f32_16x16x32_bf16 v[228:231], a[40:43], a[4:7], v[228:231]
v_mfma_f32_16x16x32_bf16 v[232:235], a[40:43], a[8:11], v[232:235]
v_mfma_f32_16x16x32_bf16 v[236:239], a[40:43], a[12:15], v[236:239]
s_waitcnt vmcnt(12) lgkmcnt(0)
s_barrier
v_mfma_f32_16x16x32_bf16 v[128:131], a[60:63], a[44:47], v[128:131]
ds_read_b64_tr_b16 a[16:17], v127 offset:0
v_mfma_f32_16x16x32_bf16 v[132:135], a[60:63], a[48:51], v[132:135]
ds_read_b64_tr_b16 a[18:19], v127 offset:2048
v_mfma_f32_16x16x32_bf16 v[136:139], a[60:63], a[52:55], v[136:139]
ds_read_b128 a[0:3], v125 offset:0
v_mfma_f32_16x16x32_bf16 v[140:143], a[60:63], a[56:59], v[140:143]
ds_read_b128 a[4:7], v125 offset:2048
v_mfma_f32_16x16x32_bf16 v[144:147], a[64:67], a[44:47], v[144:147]
ds_read_b128 a[8:11], v125 offset:4096
v_mfma_f32_16x16x32_bf16 v[148:151], a[64:67], a[48:51], v[148:151]
ds_read_b128 a[12:15], v125 offset:6144
v_mfma_f32_16x16x32_bf16 v[152:155], a[64:67], a[52:55], v[152:155]
ds_read_b64_tr_b16 a[20:21], v240 offset:0
s_lshl_b32 s50, s48, 7
v_mfma_f32_16x16x32_bf16 v[156:159], a[64:67], a[56:59], v[156:159]
ds_read_b64_tr_b16 a[22:23], v240 offset:2048
s_add_u32 s50, s50, s58
v_mfma_f32_16x16x32_bf16 v[160:163], a[68:71], a[44:47], v[160:163]
ds_read_b64_tr_b16 a[24:25], v241 offset:0
s_mul_i32 s51, s48, 229376
v_mfma_f32_16x16x32_bf16 v[164:167], a[68:71], a[48:51], v[164:167]
ds_read_b64_tr_b16 a[26:27], v241 offset:2048
s_add_u32 s51, s51, s59
v_mfma_f32_16x16x32_bf16 v[168:171], a[68:71], a[52:55], v[168:171]
ds_read_b64_tr_b16 a[28:29], v242 offset:0
s_add_u32 s48, s48, 1
v_mfma_f32_16x16x32_bf16 v[172:175], a[68:71], a[56:59], v[172:175]
ds_read_b64_tr_b16 a[30:31], v242 offset:2048
s_and_b32 s48, s48, 7
v_mfma_f32_16x16x32_bf16 v[176:179], a[72:75], a[44:47], v[176:179]
ds_read_b64_tr_b16 a[32:33], v243 offset:0
s_add_u32 m0, s53, 0
v_mfma_f32_16x16x32_bf16 v[180:183], a[72:75], a[48:51], v[180:183]
ds_read_b64_tr_b16 a[34:35], v243 offset:2048
buffer_load_dwordx4 v100, s[16:19], s50 offen offset:0 lds
v_mfma_f32_16x16x32_bf16 v[184:187], a[72:75], a[52:55], v[184:187]
ds_read_b64_tr_b16 a[36:37], v244 offset:0
v_mfma_f32_16x16x32_bf16 v[188:191], a[72:75], a[56:59], v[188:191]
ds_read_b64_tr_b16 a[38:39], v244 offset:2048
buffer_load_dwordx4 v101, s[16:19], s50 offen offset:1024 lds
v_mfma_f32_16x16x32_bf16 v[192:195], a[76:79], a[44:47], v[192:195]
ds_read_b64_tr_b16 a[40:41], v245 offset:0
v_mfma_f32_16x16x32_bf16 v[196:199], a[76:79], a[48:51], v[196:199]
ds_read_b64_tr_b16 a[42:43], v245 offset:2048
buffer_load_dwordx4 v102, s[16:19], s50 offen offset:2048 lds
v_mfma_f32_16x16x32_bf16 v[200:203], a[76:79], a[52:55], v[200:203]
v_mfma_f32_16x16x32_bf16 v[204:207], a[76:79], a[56:59], v[204:207]
buffer_load_dwordx4 v103, s[16:19], s50 offen offset:3072 lds
v_mfma_f32_16x16x32_bf16 v[208:211], a[80:83], a[44:47], v[208:211]
s_add_u32 m0, s54, 0
v_mfma_f32_16x16x32_bf16 v[212:215], a[80:83], a[48:51], v[212:215]
buffer_load_dwordx4 v104, s[20:23], s51 offen offset:0 lds
v_mfma_f32_16x16x32_bf16 v[216:219], a[80:83], a[52:55], v[216:219]
v_mfma_f32_16x16x32_bf16 v[220:223], a[80:83], a[56:59], v[220:223]
buffer_load_dwordx4 v105, s[20:23], s51 offen offset:1024 lds
v_mfma_f32_16x16x32_bf16 v[224:227], a[84:87], a[44:47], v[224:227]
v_mfma_f32_16x16x32_bf16 v[228:231], a[84:87], a[48:51], v[228:231]
v_mfma_f32_16x16x32_bf16 v[232:235], a[84:87], a[52:55], v[232:235]
v_mfma_f32_16x16x32_bf16 v[236:239], a[84:87], a[56:59], v[236:239]
s_waitcnt lgkmcnt(0)
v_mfma_f32_16x16x32_bf16 v[128:131], a[16:19], a[0:3], v[128:131]
ds_read_b64_tr_b16 a[60:61], v127 offset:16384
v_mfma_f32_16x16x32_bf16 v[132:135], a[16:19], a[4:7], v[132:135]
ds_read_b64_tr_b16 a[62:63], v127 offset:18432
v_mfma_f32_16x16x32_bf16 v[136:139], a[16:19], a[8:11], v[136:139]
ds_read_b128 a[44:47], v126 offset:0
v_mfma_f32_16x16x32_bf16 v[140:143], a[16:19], a[12:15], v[140:143]
ds_read_b128 a[48:51], v126 offset:2048
v_mfma_f32_16x16x32_bf16 v[144:147], a[20:23], a[0:3], v[144:147]
ds_read_b128 a[52:55], v126 offset:4096
v_mfma_f32_16x16x32_bf16 v[148:151], a[20:23], a[4:7], v[148:151]
ds_read_b128 a[56:59], v126 offset:6144
v_mfma_f32_16x16x32_bf16 v[152:155], a[20:23], a[8:11], v[152:155]
ds_read_b64_tr_b16 a[64:65], v240 offset:16384
v_mfma_f32_16x16x32_bf16 v[156:159], a[20:23], a[12:15], v[156:159]
ds_read_b64_tr_b16 a[66:67], v240 offset:18432
v_mfma_f32_16x16x32_bf16 v[160:163], a[24:27], a[0:3], v[160:163]
ds_read_b64_tr_b16 a[68:69], v241 offset:16384
v_mfma_f32_16x16x32_bf16 v[164:167], a[24:27], a[4:7], v[164:167]
ds_read_b64_tr_b16 a[70:71], v241 offset:18432
v_mfma_f32_16x16x32_bf16 v[168:171], a[24:27], a[8:11], v[168:171]
ds_read_b64_tr_b16 a[72:73], v242 offset:16384
v_mfma_f32_16x16x32_bf16 v[172:175], a[24:27], a[12:15], v[172:175]
ds_read_b64_tr_b16 a[74:75], v242 offset:18432
v_mfma_f32_16x16x32_bf16 v[176:179], a[28:31], a[0:3], v[176:179]
ds_read_b64_tr_b16 a[76:77], v243 offset:16384
v_mfma_f32_16x16x32_bf16 v[180:183], a[28:31], a[4:7], v[180:183]
ds_read_b64_tr_b16 a[78:79], v243 offset:18432
buffer_load_dwordx4 v106, s[20:23], s51 offen offset:2048 lds
v_mfma_f32_16x16x32_bf16 v[184:187], a[28:31], a[8:11], v[184:187]
ds_read_b64_tr_b16 a[80:81], v244 offset:16384
v_mfma_f32_16x16x32_bf16 v[188:191], a[28:31], a[12:15], v[188:191]
ds_read_b64_tr_b16 a[82:83], v244 offset:18432
buffer_load_dwordx4 v107, s[20:23], s51 offen offset:3072 lds
v_mfma_f32_16x16x32_bf16 v[192:195], a[32:35], a[0:3], v[192:195]
ds_read_b64_tr_b16 a[84:85], v245 offset:16384
s_add_u32 m0, s54, 4096
v_mfma_f32_16x16x32_bf16 v[196:199], a[32:35], a[4:7], v[196:199]
ds_read_b64_tr_b16 a[86:87], v245 offset:18432
buffer_load_dwordx4 v108, s[20:23], s51 offen offset:0 lds
v_mfma_f32_16x16x32_bf16 v[200:203], a[32:35], a[8:11], v[200:203]
v_mfma_f32_16x16x32_bf16 v[204:207], a[32:35], a[12:15], v[204:207]
buffer_load_dwordx4 v109, s[20:23], s51 offen offset:1024 lds
v_mfma_f32_16x16x32_bf16 v[208:211], a[36:39], a[0:3], v[208:211]
v_mfma_f32_16x16x32_bf16 v[212:215], a[36:39], a[4:7], v[212:215]
buffer_load_dwordx4 v110, s[20:23], s51 offen offset:2048 lds
v_mfma_f32_16x16x32_bf16 v[216:219], a[36:39], a[8:11], v[216:219]
v_mfma_f32_16x16x32_bf16 v[220:223], a[36:39], a[12:15], v[220:223]
buffer_load_dwordx4 v111, s[20:23], s51 offen offset:3072 lds
v_mfma_f32_16x16x32_bf16 v[224:227], a[40:43], a[0:3], v[224:227]
v_mfma_f32_16x16x32_bf16 v[228:231], a[40:43], a[4:7], v[228:231]
v_mfma_f32_16x16x32_bf16 v[232:235], a[40:43], a[8:11], v[232:235]
v_mfma_f32_16x16x32_bf16 v[236:239], a[40:43], a[12:15], v[236:239]
s_waitcnt vmcnt(12) lgkmcnt(0)
s_barrier
v_mfma_f32_16x16x32_bf16 v[128:131], a[60:63], a[44:47], v[128:131]
ds_read_b64_tr_b16 a[16:17], v248 offset:0
s_mul_i32 s62, s42, 7168
v_mfma_f32_16x16x32_bf16 v[132:135], a[60:63], a[48:51], v[132:135]
ds_read_b64_tr_b16 a[18:19], v248 offset:2048
s_sub_u32 s62, s57, s62
v_mfma_f32_16x16x32_bf16 v[136:139], a[60:63], a[52:55], v[136:139]
ds_read_b128 a[0:3], v246 offset:0
s_lshl_b32 s64, s40, 12
v_mfma_f32_16x16x32_bf16 v[140:143], a[60:63], a[56:59], v[140:143]
ds_read_b128 a[4:7], v246 offset:2048
s_add_u32 s62, s62, s64
v_mfma_f32_16x16x32_bf16 v[144:147], a[64:67], a[44:47], v[144:147]
ds_read_b128 a[8:11], v246 offset:4096
s_add_u32 s64, s64, 147456
v_mfma_f32_16x16x32_bf16 v[148:151], a[64:67], a[48:51], v[148:151]
ds_read_b128 a[12:15], v246 offset:6144
s_lshl_b32 s63, s43, 10
v_mfma_f32_16x16x32_bf16 v[152:155], a[64:67], a[52:55], v[152:155]
ds_read_b64_tr_b16 a[20:21], v249 offset:0
s_lshl_b32 s50, s48, 7
s_add_u32 s65, s62, 3072
v_mfma_f32_16x16x32_bf16 v[156:159], a[64:67], a[56:59], v[156:159]
ds_read_b64_tr_b16 a[22:23], v249 offset:2048
s_add_u32 s50, s50, s58
s_cmp_eq_u32 s40, 3
s_cselect_b32 s63, s63, s65
v_mfma_f32_16x16x32_bf16 v[160:163], a[68:71], a[44:47], v[160:163]
ds_read_b64_tr_b16 a[24:25], v250 offset:0
s_mul_i32 s51, s48, 229376
v_mfma_f32_16x16x32_bf16 v[164:167], a[68:71], a[48:51], v[164:167]
ds_read_b64_tr_b16 a[26:27], v250 offset:2048
s_add_u32 s51, s51, s59
v_mfma_f32_16x16x32_bf16 v[168:171], a[68:71], a[52:55], v[168:171]
ds_read_b64_tr_b16 a[28:29], v251 offset:0
s_add_u32 s48, s48, 1
v_mfma_f32_16x16x32_bf16 v[172:175], a[68:71], a[56:59], v[172:175]
ds_read_b64_tr_b16 a[30:31], v251 offset:2048
s_and_b32 s48, s48, 7
v_mfma_f32_16x16x32_bf16 v[176:179], a[72:75], a[44:47], v[176:179]
ds_read_b64_tr_b16 a[32:33], v252 offset:0
s_add_u32 m0, s53, 49152
v_mfma_f32_16x16x32_bf16 v[180:183], a[72:75], a[48:51], v[180:183]
ds_read_b64_tr_b16 a[34:35], v252 offset:2048
buffer_load_dwordx4 v100, s[16:19], s50 offen offset:0 lds
v_mfma_f32_16x16x32_bf16 v[184:187], a[72:75], a[52:55], v[184:187]
ds_read_b64_tr_b16 a[36:37], v253 offset:0
v_mfma_f32_16x16x32_bf16 v[188:191], a[72:75], a[56:59], v[188:191]
ds_read_b64_tr_b16 a[38:39], v253 offset:2048
buffer_load_dwordx4 v101, s[16:19], s50 offen offset:1024 lds
v_mfma_f32_16x16x32_bf16 v[192:195], a[76:79], a[44:47], v[192:195]
ds_read_b64_tr_b16 a[40:41], v254 offset:0
v_mfma_f32_16x16x32_bf16 v[196:199], a[76:79], a[48:51], v[196:199]
ds_read_b64_tr_b16 a[42:43], v254 offset:2048
buffer_load_dwordx4 v102, s[16:19], s50 offen offset:2048 lds
v_mfma_f32_16x16x32_bf16 v[200:203], a[76:79], a[52:55], v[200:203]
v_mfma_f32_16x16x32_bf16 v[204:207], a[76:79], a[56:59], v[204:207]
buffer_load_dwordx4 v103, s[16:19], s50 offen offset:3072 lds
v_mfma_f32_16x16x32_bf16 v[208:211], a[80:83], a[44:47], v[208:211]
s_add_u32 m0, s54, 49152
v_mfma_f32_16x16x32_bf16 v[212:215], a[80:83], a[48:51], v[212:215]
buffer_load_dwordx4 v104, s[20:23], s51 offen offset:0 lds
v_mfma_f32_16x16x32_bf16 v[216:219], a[80:83], a[52:55], v[216:219]
v_mfma_f32_16x16x32_bf16 v[220:223], a[80:83], a[56:59], v[220:223]
buffer_load_dwordx4 v105, s[20:23], s51 offen offset:1024 lds
v_mfma_f32_16x16x32_bf16 v[224:227], a[84:87], a[44:47], v[224:227]
v_mfma_f32_16x16x32_bf16 v[228:231], a[84:87], a[48:51], v[228:231]
v_mfma_f32_16x16x32_bf16 v[232:235], a[84:87], a[52:55], v[232:235]
v_mfma_f32_16x16x32_bf16 v[236:239], a[84:87], a[56:59], v[236:239]
s_waitcnt lgkmcnt(0)
v_mfma_f32_16x16x32_bf16 v[128:131], a[16:19], a[0:3], v[128:131]
ds_read_b64_tr_b16 a[60:61], v248 offset:16384
s_mov_b32 s65, m0
s_mov_b32 m0, s64
v_mfma_f32_16x16x32_bf16 v[132:135], a[16:19], a[4:7], v[132:135]
ds_read_b64_tr_b16 a[62:63], v248 offset:18432
buffer_load_dwordx4 v95, s[24:27], s62 offen offset:0 sc1 lds
v_mfma_f32_16x16x32_bf16 v[136:139], a[16:19], a[8:11], v[136:139]
ds_read_b128 a[44:47], v247 offset:0
v_mfma_f32_16x16x32_bf16 v[140:143], a[16:19], a[12:15], v[140:143]
ds_read_b128 a[48:51], v247 offset:2048
buffer_load_dwordx4 v95, s[24:27], s62 offen offset:1024 sc1 lds
v_mfma_f32_16x16x32_bf16 v[144:147], a[20:23], a[0:3], v[144:147]
ds_read_b128 a[52:55], v247 offset:4096
v_mfma_f32_16x16x32_bf16 v[148:151], a[20:23], a[4:7], v[148:151]
ds_read_b128 a[56:59], v247 offset:6144
buffer_load_dwordx4 v95, s[24:27], s62 offen offset:2048 sc1 lds
v_mfma_f32_16x16x32_bf16 v[152:155], a[20:23], a[8:11], v[152:155]
ds_read_b64_tr_b16 a[64:65], v249 offset:16384
s_add_u32 m0, s64, 3072
v_mfma_f32_16x16x32_bf16 v[156:159], a[20:23], a[12:15], v[156:159]
ds_read_b64_tr_b16 a[66:67], v249 offset:18432
buffer_load_dwordx4 v95, s[24:27], s63 offen offset:0 sc1 lds
v_mfma_f32_16x16x32_bf16 v[160:163], a[24:27], a[0:3], v[160:163]
ds_read_b64_tr_b16 a[68:69], v250 offset:16384
s_mov_b32 m0, s65
v_mfma_f32_16x16x32_bf16 v[164:167], a[24:27], a[4:7], v[164:167]
ds_read_b64_tr_b16 a[70:71], v250 offset:18432
v_mfma_f32_16x16x32_bf16 v[168:171], a[24:27], a[8:11], v[168:171]
ds_read_b64_tr_b16 a[72:73], v251 offset:16384
v_mfma_f32_16x16x32_bf16 v[172:175], a[24:27], a[12:15], v[172:175]
ds_read_b64_tr_b16 a[74:75], v251 offset:18432
v_mfma_f32_16x16x32_bf16 v[176:179], a[28:31], a[0:3], v[176:179]
ds_read_b64_tr_b16 a[76:77], v252 offset:16384
v_mfma_f32_16x16x32_bf16 v[180:183], a[28:31], a[4:7], v[180:183]
ds_read_b64_tr_b16 a[78:79], v252 offset:18432
buffer_load_dwordx4 v106, s[20:23], s51 offen offset:2048 lds
v_mfma_f32_16x16x32_bf16 v[184:187], a[28:31], a[8:11], v[184:187]
ds_read_b64_tr_b16 a[80:81], v253 offset:16384
v_mfma_f32_16x16x32_bf16 v[188:191], a[28:31], a[12:15], v[188:191]
ds_read_b64_tr_b16 a[82:83], v253 offset:18432
buffer_load_dwordx4 v107, s[20:23], s51 offen offset:3072 lds
v_mfma_f32_16x16x32_bf16 v[192:195], a[32:35], a[0:3], v[192:195]
ds_read_b64_tr_b16 a[84:85], v254 offset:16384
s_add_u32 m0, s54, 53248
v_mfma_f32_16x16x32_bf16 v[196:199], a[32:35], a[4:7], v[196:199]
ds_read_b64_tr_b16 a[86:87], v254 offset:18432
buffer_load_dwordx4 v108, s[20:23], s51 offen offset:0 lds
v_mfma_f32_16x16x32_bf16 v[200:203], a[32:35], a[8:11], v[200:203]
v_mfma_f32_16x16x32_bf16 v[204:207], a[32:35], a[12:15], v[204:207]
buffer_load_dwordx4 v109, s[20:23], s51 offen offset:1024 lds
v_mfma_f32_16x16x32_bf16 v[208:211], a[36:39], a[0:3], v[208:211]
v_mfma_f32_16x16x32_bf16 v[212:215], a[36:39], a[4:7], v[212:215]
buffer_load_dwordx4 v110, s[20:23], s51 offen offset:2048 lds
v_mfma_f32_16x16x32_bf16 v[216:219], a[36:39], a[8:11], v[216:219]
v_mfma_f32_16x16x32_bf16 v[220:223], a[36:39], a[12:15], v[220:223]
buffer_load_dwordx4 v111, s[20:23], s51 offen offset:3072 lds
v_mfma_f32_16x16x32_bf16 v[224:227], a[40:43], a[0:3], v[224:227]
v_mfma_f32_16x16x32_bf16 v[228:231], a[40:43], a[4:7], v[228:231]
v_mfma_f32_16x16x32_bf16 v[232:235], a[40:43], a[8:11], v[232:235]
v_mfma_f32_16x16x32_bf16 v[236:239], a[40:43], a[12:15], v[236:239]
s_waitcnt vmcnt(16) lgkmcnt(0)
s_barrier
v_mfma_f32_16x16x32_bf16 v[128:131], a[60:63], a[44:47], v[128:131]
ds_read_b64_tr_b16 a[16:17], v118 offset:0
s_mul_i32 s62, s42, 7168
v_mfma_f32_16x16x32_bf16 v[132:135], a[60:63], a[48:51], v[132:135]
ds_read_b64_tr_b16 a[18:19], v118 offset:2048
s_add_u32 s62, s62, 147456
v_mfma_f32_16x16x32_bf16 v[136:139], a[60:63], a[52:55], v[136:139]
ds_read_b128 a[0:3], v116 offset:0
v_add_u32 v16, s62, v95
v_mfma_f32_16x16x32_bf16 v[140:143], a[60:63], a[56:59], v[140:143]
ds_read_b128 a[4:7], v116 offset:2048
s_lshl_b32 s62, s41, 9
v_mfma_f32_16x16x32_bf16 v[144:147], a[64:67], a[44:47], v[144:147]
ds_read_b128 a[8:11], v116 offset:4096
s_add_u32 s62, s62, 162816
v_mfma_f32_16x16x32_bf16 v[148:151], a[64:67], a[48:51], v[148:151]
ds_read_b128 a[12:15], v116 offset:6144
v_add_u32 v17, s62, v94
v_mfma_f32_16x16x32_bf16 v[152:155], a[64:67], a[52:55], v[152:155]
ds_read_b64_tr_b16 a[20:21], v119 offset:0
v_mfma_f32_16x16x32_bf16 v[156:159], a[64:67], a[56:59], v[156:159]
ds_read_b64_tr_b16 a[22:23], v119 offset:2048
v_mfma_f32_16x16x32_bf16 v[160:163], a[68:71], a[44:47], v[160:163]
ds_read_b64_tr_b16 a[24:25], v120 offset:0
v_mfma_f32_16x16x32_bf16 v[164:167], a[68:71], a[48:51], v[164:167]
ds_read_b64_tr_b16 a[26:27], v120 offset:2048
v_mfma_f32_16x16x32_bf16 v[168:171], a[68:71], a[52:55], v[168:171]
ds_read_b64_tr_b16 a[28:29], v121 offset:0
s_add_u32 m0, s55, 98304
v_mfma_f32_16x16x32_bf16 v[172:175], a[68:71], a[56:59], v[172:175]
ds_read_b64_tr_b16 a[30:31], v121 offset:2048
s_add_u32 s50, s12, 0
v_mfma_f32_16x16x32_bf16 v[176:179], a[72:75], a[44:47], v[176:179]
ds_read_b64_tr_b16 a[32:33], v122 offset:0
s_add_u32 s51, s12, 0
v_mfma_f32_16x16x32_bf16 v[180:183], a[72:75], a[48:51], v[180:183]
ds_read_b64_tr_b16 a[34:35], v122 offset:2048
buffer_load_dwordx4 v112, s[72:75], s50 offen offset:0 lds
v_mfma_f32_16x16x32_bf16 v[184:187], a[72:75], a[52:55], v[184:187]
ds_read_b64_tr_b16 a[36:37], v123 offset:0
v_mfma_f32_16x16x32_bf16 v[188:191], a[72:75], a[56:59], v[188:191]
ds_read_b64_tr_b16 a[38:39], v123 offset:2048
buffer_load_dwordx4 v113, s[72:75], s50 offen offset:1024 lds
v_mfma_f32_16x16x32_bf16 v[192:195], a[76:79], a[44:47], v[192:195]
ds_read_b64_tr_b16 a[40:41], v124 offset:0
v_mfma_f32_16x16x32_bf16 v[196:199], a[76:79], a[48:51], v[196:199]
ds_read_b64_tr_b16 a[42:43], v124 offset:2048
buffer_load_dwordx4 v114, s[72:75], s51 offen offset:2048 lds
v_mfma_f32_16x16x32_bf16 v[200:203], a[76:79], a[52:55], v[200:203]
v_mfma_f32_16x16x32_bf16 v[204:207], a[76:79], a[56:59], v[204:207]
buffer_load_dwordx4 v115, s[72:75], s51 offen offset:3072 lds
s_add_u32 m0, s55, 102400
s_add_u32 s50, s12, 32768
v_mfma_f32_16x16x32_bf16 v[208:211], a[80:83], a[44:47], v[208:211]
s_add_u32 s51, s12, 32768
v_mfma_f32_16x16x32_bf16 v[212:215], a[80:83], a[48:51], v[212:215]
buffer_load_dwordx4 v112, s[72:75], s50 offen offset:0 lds
v_mfma_f32_16x16x32_bf16 v[216:219], a[80:83], a[52:55], v[216:219]
v_mfma_f32_16x16x32_bf16 v[220:223], a[80:83], a[56:59], v[220:223]
buffer_load_dwordx4 v113, s[72:75], s50 offen offset:1024 lds
v_mfma_f32_16x16x32_bf16 v[224:227], a[84:87], a[44:47], v[224:227]
v_mfma_f32_16x16x32_bf16 v[228:231], a[84:87], a[48:51], v[228:231]
v_mfma_f32_16x16x32_bf16 v[232:235], a[84:87], a[52:55], v[232:235]
v_mfma_f32_16x16x32_bf16 v[236:239], a[84:87], a[56:59], v[236:239]
s_waitcnt lgkmcnt(0)
v_mfma_f32_16x16x32_bf16 v[128:131], a[16:19], a[0:3], v[128:131]
ds_read_b64_tr_b16 a[60:61], v118 offset:16384
v_mfma_f32_16x16x32_bf16 v[132:135], a[16:19], a[4:7], v[132:135]
ds_read_b64_tr_b16 a[62:63], v118 offset:18432
v_mfma_f32_16x16x32_bf16 v[136:139], a[16:19], a[8:11], v[136:139]
ds_read_b128 a[44:47], v117 offset:0
v_mfma_f32_16x16x32_bf16 v[140:143], a[16:19], a[12:15], v[140:143]
ds_read_b128 a[48:51], v117 offset:2048
v_mfma_f32_16x16x32_bf16 v[144:147], a[20:23], a[0:3], v[144:147]
ds_read_b128 a[52:55], v117 offset:4096
v_mfma_f32_16x16x32_bf16 v[148:151], a[20:23], a[4:7], v[148:151]
ds_read_b128 a[56:59], v117 offset:6144
v_mfma_f32_16x16x32_bf16 v[152:155], a[20:23], a[8:11], v[152:155]
ds_read_b64_tr_b16 a[64:65], v119 offset:16384
v_mfma_f32_16x16x32_bf16 v[156:159], a[20:23], a[12:15], v[156:159]
ds_read_b64_tr_b16 a[66:67], v119 offset:18432
v_mfma_f32_16x16x32_bf16 v[160:163], a[24:27], a[0:3], v[160:163]
ds_read_b64_tr_b16 a[68:69], v120 offset:16384
v_mfma_f32_16x16x32_bf16 v[164:167], a[24:27], a[4:7], v[164:167]
ds_read_b64_tr_b16 a[70:71], v120 offset:18432
v_mfma_f32_16x16x32_bf16 v[168:171], a[24:27], a[8:11], v[168:171]
ds_read_b64_tr_b16 a[72:73], v121 offset:16384
v_mfma_f32_16x16x32_bf16 v[172:175], a[24:27], a[12:15], v[172:175]
ds_read_b64_tr_b16 a[74:75], v121 offset:18432
v_mfma_f32_16x16x32_bf16 v[176:179], a[28:31], a[0:3], v[176:179]
ds_read_b64_tr_b16 a[76:77], v122 offset:16384
v_mfma_f32_16x16x32_bf16 v[180:183], a[28:31], a[4:7], v[180:183]
ds_read_b64_tr_b16 a[78:79], v122 offset:18432
buffer_load_dwordx4 v114, s[72:75], s51 offen offset:2048 lds
v_mfma_f32_16x16x32_bf16 v[184:187], a[28:31], a[8:11], v[184:187]
ds_read_b64_tr_b16 a[80:81], v123 offset:16384
v_mfma_f32_16x16x32_bf16 v[188:191], a[28:31], a[12:15], v[188:191]
ds_read_b64_tr_b16 a[82:83], v123 offset:18432
buffer_load_dwordx4 v115, s[72:75], s51 offen offset:3072 lds
s_add_u32 m0, s55, 106496
s_add_u32 s50, s12, 65536
v_mfma_f32_16x16x32_bf16 v[192:195], a[32:35], a[0:3], v[192:195]
ds_read_b64_tr_b16 a[84:85], v124 offset:16384
s_add_u32 s51, s12, 65536
v_mfma_f32_16x16x32_bf16 v[196:199], a[32:35], a[4:7], v[196:199]
ds_read_b64_tr_b16 a[86:87], v124 offset:18432
buffer_load_dwordx4 v112, s[72:75], s50 offen offset:0 lds
v_mfma_f32_16x16x32_bf16 v[200:203], a[32:35], a[8:11], v[200:203]
v_mfma_f32_16x16x32_bf16 v[204:207], a[32:35], a[12:15], v[204:207]
buffer_load_dwordx4 v113, s[72:75], s50 offen offset:1024 lds
v_mfma_f32_16x16x32_bf16 v[208:211], a[36:39], a[0:3], v[208:211]
v_mfma_f32_16x16x32_bf16 v[212:215], a[36:39], a[4:7], v[212:215]
buffer_load_dwordx4 v114, s[72:75], s51 offen offset:2048 lds
v_mfma_f32_16x16x32_bf16 v[216:219], a[36:39], a[8:11], v[216:219]
v_mfma_f32_16x16x32_bf16 v[220:223], a[36:39], a[12:15], v[220:223]
buffer_load_dwordx4 v115, s[72:75], s51 offen offset:3072 lds
v_mfma_f32_16x16x32_bf16 v[224:227], a[40:43], a[0:3], v[224:227]
v_mfma_f32_16x16x32_bf16 v[228:231], a[40:43], a[4:7], v[228:231]
v_mfma_f32_16x16x32_bf16 v[232:235], a[40:43], a[8:11], v[232:235]
v_mfma_f32_16x16x32_bf16 v[236:239], a[40:43], a[12:15], v[236:239]
s_waitcnt vmcnt(12) lgkmcnt(0)
s_barrier
v_mfma_f32_16x16x32_bf16 v[128:131], a[60:63], a[44:47], v[128:131]
ds_read_b64_tr_b16 a[16:17], v127 offset:0
v_mfma_f32_16x16x32_bf16 v[132:135], a[60:63], a[48:51], v[132:135]
ds_read_b64_tr_b16 a[18:19], v127 offset:2048
v_mfma_f32_16x16x32_bf16 v[136:139], a[60:63], a[52:55], v[136:139]
ds_read_b128 a[0:3], v125 offset:0
v_mfma_f32_16x16x32_bf16 v[140:143], a[60:63], a[56:59], v[140:143]
ds_read_b128 a[4:7], v125 offset:2048
v_mfma_f32_16x16x32_bf16 v[144:147], a[64:67], a[44:47], v[144:147]
ds_read_b128 a[8:11], v125 offset:4096
v_mfma_f32_16x16x32_bf16 v[148:151], a[64:67], a[48:51], v[148:151]
ds_read_b128 a[12:15], v125 offset:6144
v_mfma_f32_16x16x32_bf16 v[152:155], a[64:67], a[52:55], v[152:155]
ds_read_b64_tr_b16 a[20:21], v240 offset:0
v_mfma_f32_16x16x32_bf16 v[156:159], a[64:67], a[56:59], v[156:159]
ds_read_b64_tr_b16 a[22:23], v240 offset:2048
v_mfma_f32_16x16x32_bf16 v[160:163], a[68:71], a[44:47], v[160:163]
ds_read_b64_tr_b16 a[24:25], v241 offset:0
v_mfma_f32_16x16x32_bf16 v[164:167], a[68:71], a[48:51], v[164:167]
ds_read_b64_tr_b16 a[26:27], v241 offset:2048
v_mfma_f32_16x16x32_bf16 v[168:171], a[68:71], a[52:55], v[168:171]
ds_read_b64_tr_b16 a[28:29], v242 offset:0
s_add_u32 m0, s55, 0
v_mfma_f32_16x16x32_bf16 v[172:175], a[68:71], a[56:59], v[172:175]
ds_read_b64_tr_b16 a[30:31], v242 offset:2048
s_add_u32 s50, s13, 0
v_mfma_f32_16x16x32_bf16 v[176:179], a[72:75], a[44:47], v[176:179]
ds_read_b64_tr_b16 a[32:33], v243 offset:0
s_add_u32 s51, s13, 0
v_mfma_f32_16x16x32_bf16 v[180:183], a[72:75], a[48:51], v[180:183]
ds_read_b64_tr_b16 a[34:35], v243 offset:2048
buffer_load_dwordx4 v112, s[72:75], s50 offen offset:0 lds
v_mfma_f32_16x16x32_bf16 v[184:187], a[72:75], a[52:55], v[184:187]
ds_read_b64_tr_b16 a[36:37], v244 offset:0
v_mfma_f32_16x16x32_bf16 v[188:191], a[72:75], a[56:59], v[188:191]
ds_read_b64_tr_b16 a[38:39], v244 offset:2048
buffer_load_dwordx4 v113, s[72:75], s50 offen offset:1024 lds
v_mfma_f32_16x16x32_bf16 v[192:195], a[76:79], a[44:47], v[192:195]
ds_read_b64_tr_b16 a[40:41], v245 offset:0
v_mfma_f32_16x16x32_bf16 v[196:199], a[76:79], a[48:51], v[196:199]
ds_read_b64_tr_b16 a[42:43], v245 offset:2048
buffer_load_dwordx4 v114, s[72:75], s51 offen offset:2048 lds
v_mfma_f32_16x16x32_bf16 v[200:203], a[76:79], a[52:55], v[200:203]
ds_read_b64 v[56:57], v17 offset:0
v_mfma_f32_16x16x32_bf16 v[204:207], a[76:79], a[56:59], v[204:207]
buffer_load_dwordx4 v115, s[72:75], s51 offen offset:3072 lds
s_add_u32 m0, s55, 4096
s_add_u32 s50, s13, 32768
ds_read_b64 v[58:59], v17 offset:128
v_mfma_f32_16x16x32_bf16 v[208:211], a[80:83], a[44:47], v[208:211]
s_add_u32 s51, s13, 32768
ds_read_b64 v[60:61], v17 offset:256
v_mfma_f32_16x16x32_bf16 v[212:215], a[80:83], a[48:51], v[212:215]
buffer_load_dwordx4 v112, s[72:75], s50 offen offset:0 lds
ds_read_b64 v[62:63], v17 offset:384
v_mfma_f32_16x16x32_bf16 v[216:219], a[80:83], a[52:55], v[216:219]
ds_read_b128 v[64:67], v16 offset:0
v_mfma_f32_16x16x32_bf16 v[220:223], a[80:83], a[56:59], v[220:223]
buffer_load_dwordx4 v113, s[72:75], s50 offen offset:1024 lds
v_mfma_f32_16x16x32_bf16 v[224:227], a[84:87], a[44:47], v[224:227]
v_mfma_f32_16x16x32_bf16 v[228:231], a[84:87], a[48:51], v[228:231]
v_mfma_f32_16x16x32_bf16 v[232:235], a[84:87], a[52:55], v[232:235]
v_mfma_f32_16x16x32_bf16 v[236:239], a[84:87], a[56:59], v[236:239]
s_waitcnt lgkmcnt(0)
v_mfma_f32_16x16x32_bf16 v[128:131], a[16:19], a[0:3], v[128:131]
ds_read_b64_tr_b16 a[60:61], v127 offset:16384
v_mfma_f32_16x16x32_bf16 v[132:135], a[16:19], a[4:7], v[132:135]
ds_read_b64_tr_b16 a[62:63], v127 offset:18432
v_mfma_f32_16x16x32_bf16 v[136:139], a[16:19], a[8:11], v[136:139]
ds_read_b128 a[44:47], v126 offset:0
v_mfma_f32_16x16x32_bf16 v[140:143], a[16:19], a[12:15], v[140:143]
ds_read_b128 a[48:51], v126 offset:2048
v_mfma_f32_16x16x32_bf16 v[144:147], a[20:23], a[0:3], v[144:147]
ds_read_b128 a[52:55], v126 offset:4096
v_mfma_f32_16x16x32_bf16 v[148:151], a[20:23], a[4:7], v[148:151]
ds_read_b128 a[56:59], v126 offset:6144
v_mfma_f32_16x16x32_bf16 v[152:155], a[20:23], a[8:11], v[152:155]
ds_read_b64_tr_b16 a[64:65], v240 offset:16384
v_mfma_f32_16x16x32_bf16 v[156:159], a[20:23], a[12:15], v[156:159]
ds_read_b64_tr_b16 a[66:67], v240 offset:18432
v_mfma_f32_16x16x32_bf16 v[160:163], a[24:27], a[0:3], v[160:163]
ds_read_b64_tr_b16 a[68:69], v241 offset:16384
v_mfma_f32_16x16x32_bf16 v[164:167], a[24:27], a[4:7], v[164:167]
ds_read_b64_tr_b16 a[70:71], v241 offset:18432
v_mfma_f32_16x16x32_bf16 v[168:171], a[24:27], a[8:11], v[168:171]
ds_read_b64_tr_b16 a[72:73], v242 offset:16384
v_mfma_f32_16x16x32_bf16 v[172:175], a[24:27], a[12:15], v[172:175]
ds_read_b64_tr_b16 a[74:75], v242 offset:18432
v_mfma_f32_16x16x32_bf16 v[176:179], a[28:31], a[0:3], v[176:179]
ds_read_b64_tr_b16 a[76:77], v243 offset:16384
v_mfma_f32_16x16x32_bf16 v[180:183], a[28:31], a[4:7], v[180:183]
ds_read_b64_tr_b16 a[78:79], v243 offset:18432
buffer_load_dwordx4 v114, s[72:75], s51 offen offset:2048 lds
v_mfma_f32_16x16x32_bf16 v[184:187], a[28:31], a[8:11], v[184:187]
ds_read_b64_tr_b16 a[80:81], v244 offset:16384
v_mfma_f32_16x16x32_bf16 v[188:191], a[28:31], a[12:15], v[188:191]
ds_read_b64_tr_b16 a[82:83], v244 offset:18432
buffer_load_dwordx4 v115, s[72:75], s51 offen offset:3072 lds
s_add_u32 m0, s55, 8192
s_add_u32 s50, s13, 65536
v_mfma_f32_16x16x32_bf16 v[192:195], a[32:35], a[0:3], v[192:195]
ds_read_b64_tr_b16 a[84:85], v245 offset:16384
s_add_u32 s51, s13, 65536
v_mfma_f32_16x16x32_bf16 v[196:199], a[32:35], a[4:7], v[196:199]
ds_read_b64_tr_b16 a[86:87], v245 offset:18432
buffer_load_dwordx4 v112, s[72:75], s50 offen offset:0 lds
v_mfma_f32_16x16x32_bf16 v[200:203], a[32:35], a[8:11], v[200:203]
ds_read_b128 v[68:71], v16 offset:1024
v_mfma_f32_16x16x32_bf16 v[204:207], a[32:35], a[12:15], v[204:207]
buffer_load_dwordx4 v113, s[72:75], s50 offen offset:1024 lds
ds_read_b128 v[72:75], v16 offset:2048
v_mfma_f32_16x16x32_bf16 v[208:211], a[36:39], a[0:3], v[208:211]
ds_read_b128 v[76:79], v16 offset:3072
v_mfma_f32_16x16x32_bf16 v[212:215], a[36:39], a[4:7], v[212:215]
buffer_load_dwordx4 v114, s[72:75], s51 offen offset:2048 lds
ds_read_b128 v[80:83], v16 offset:4096
v_mfma_f32_16x16x32_bf16 v[216:219], a[36:39], a[8:11], v[216:219]
ds_read_b128 v[84:87], v16 offset:5120
v_mfma_f32_16x16x32_bf16 v[220:223], a[36:39], a[12:15], v[220:223]
buffer_load_dwordx4 v115, s[72:75], s51 offen offset:3072 lds
ds_read_b128 v[88:91], v16 offset:6144
v_mfma_f32_16x16x32_bf16 v[224:227], a[40:43], a[0:3], v[224:227]
v_mfma_f32_16x16x32_bf16 v[228:231], a[40:43], a[4:7], v[228:231]
v_mfma_f32_16x16x32_bf16 v[232:235], a[40:43], a[8:11], v[232:235]
v_mfma_f32_16x16x32_bf16 v[236:239], a[40:43], a[12:15], v[236:239]
s_waitcnt vmcnt(12) lgkmcnt(0)
s_barrier
v_mfma_f32_16x16x32_bf16 v[128:131], a[60:63], a[44:47], v[128:131]
ds_read_b64_tr_b16 a[112:113], v12 offset:0
v_mfma_f32_16x16x32_bf16 v[132:135], a[60:63], a[48:51], v[132:135]
ds_read_b64_tr_b16 a[114:115], v12 offset:2048
v_mfma_f32_16x16x32_bf16 v[136:139], a[60:63], a[52:55], v[136:139]
ds_read_b64_tr_b16 a[116:117], v13 offset:0
v_mfma_f32_16x16x32_bf16 v[140:143], a[60:63], a[56:59], v[140:143]
ds_read_b64_tr_b16 a[118:119], v13 offset:2048
v_mfma_f32_16x16x32_bf16 v[144:147], a[64:67], a[44:47], v[144:147]
ds_read_b64_tr_b16 a[120:121], v14 offset:0
v_mfma_f32_16x16x32_bf16 v[148:151], a[64:67], a[48:51], v[148:151]
ds_read_b64_tr_b16 a[122:123], v14 offset:2048
v_mfma_f32_16x16x32_bf16 v[152:155], a[64:67], a[52:55], v[152:155]
ds_read_b64_tr_b16 a[124:125], v15 offset:0
v_mfma_f32_16x16x32_bf16 v[156:159], a[64:67], a[56:59], v[156:159]
ds_read_b64_tr_b16 a[126:127], v15 offset:2048
v_mfma_f32_16x16x32_bf16 v[160:163], a[68:71], a[44:47], v[160:163]
ds_read_b64_tr_b16 a[128:129], v12 offset:4096
v_mfma_f32_16x16x32_bf16 v[164:167], a[68:71], a[48:51], v[164:167]
ds_read_b64_tr_b16 a[130:131], v12 offset:6144
v_mfma_f32_16x16x32_bf16 v[168:171], a[68:71], a[52:55], v[168:171]
ds_read_b64_tr_b16 a[132:133], v13 offset:4096
s_add_u32 m0, s55, 49152
v_mfma_f32_16x16x32_bf16 v[172:175], a[68:71], a[56:59], v[172:175]
ds_read_b64_tr_b16 a[134:135], v13 offset:6144
s_add_u32 s50, s14, 0
v_mfma_f32_16x16x32_bf16 v[176:179], a[72:75], a[44:47], v[176:179]
ds_read_b64_tr_b16 a[136:137], v14 offset:4096
s_add_u32 s51, s14, 0
v_mfma_f32_16x16x32_bf16 v[180:183], a[72:75], a[48:51], v[180:183]
ds_read_b64_tr_b16 a[138:139], v14 offset:6144
buffer_load_dwordx4 v112, s[72:75], s50 offen offset:0 lds
v_mfma_f32_16x16x32_bf16 v[184:187], a[72:75], a[52:55], v[184:187]
ds_read_b64_tr_b16 a[140:141], v15 offset:4096
v_mfma_f32_16x16x32_bf16 v[188:191], a[72:75], a[56:59], v[188:191]
ds_read_b64_tr_b16 a[142:143], v15 offset:6144
buffer_load_dwordx4 v113, s[72:75], s50 offen offset:1024 lds
v_mfma_f32_16x16x32_bf16 v[192:195], a[76:79], a[44:47], v[192:195]
ds_read_b64_tr_b16 a[144:145], v12 offset:8192
v_mfma_f32_16x16x32_bf16 v[196:199], a[76:79], a[48:51], v[196:199]
ds_read_b64_tr_b16 a[146:147], v12 offset:10240
buffer_load_dwordx4 v114, s[72:75], s51 offen offset:2048 lds
v_mfma_f32_16x16x32_bf16 v[200:203], a[76:79], a[52:55], v[200:203]
ds_read_b64_tr_b16 a[148:149], v13 offset:8192
v_mfma_f32_16x16x32_bf16 v[204:207], a[76:79], a[56:59], v[204:207]
ds_read_b64_tr_b16 a[150:151], v13 offset:10240
buffer_load_dwordx4 v115, s[72:75], s51 offen offset:3072 lds
s_add_u32 m0, s55, 53248
s_add_u32 s50, s14, 32768
v_mfma_f32_16x16x32_bf16 v[208:211], a[80:83], a[44:47], v[208:211]
ds_read_b64_tr_b16 a[152:153], v14 offset:8192
s_add_u32 s51, s14, 32768
v_mfma_f32_16x16x32_bf16 v[212:215], a[80:83], a[48:51], v[212:215]
ds_read_b64_tr_b16 a[154:155], v14 offset:10240
buffer_load_dwordx4 v112, s[72:75], s50 offen offset:0 lds
v_mfma_f32_16x16x32_bf16 v[216:219], a[80:83], a[52:55], v[216:219]
ds_read_b64_tr_b16 a[156:157], v15 offset:8192
v_mfma_f32_16x16x32_bf16 v[220:223], a[80:83], a[56:59], v[220:223]
ds_read_b64_tr_b16 a[158:159], v15 offset:10240
buffer_load_dwordx4 v113, s[72:75], s50 offen offset:1024 lds
v_mfma_f32_16x16x32_bf16 v[224:227], a[84:87], a[44:47], v[224:227]
v_mfma_f32_16x16x32_bf16 v[228:231], a[84:87], a[48:51], v[228:231]
v_mfma_f32_16x16x32_bf16 v[232:235], a[84:87], a[52:55], v[232:235]
v_mfma_f32_16x16x32_bf16 v[236:239], a[84:87], a[56:59], v[236:239]
buffer_load_dwordx4 v114, s[72:75], s51 offen offset:2048 lds
buffer_load_dwordx4 v115, s[72:75], s51 offen offset:3072 lds
s_add_u32 m0, s55, 57344
s_add_u32 s50, s14, 65536
s_add_u32 s51, s14, 65536
buffer_load_dwordx4 v112, s[72:75], s50 offen offset:0 lds
buffer_load_dwordx4 v113, s[72:75], s50 offen offset:1024 lds
buffer_load_dwordx4 v114, s[72:75], s51 offen offset:2048 lds
buffer_load_dwordx4 v115, s[72:75], s51 offen offset:3072 lds
s_mov_b32 s61, 0
L_cchkh:
v_min_u32 v18, v57, v59
v_max_u32 v19, v57, v59
v_min3_u32 v18, v18, v61, v63
v_max3_u32 v19, v19, v61, v63
v_min3_u32 v18, v18, v65, v69
v_max3_u32 v19, v19, v65, v69
v_min3_u32 v18, v18, v73, v77
v_max3_u32 v19, v19, v73, v77
v_min3_u32 v18, v18, v81, v85
v_max3_u32 v19, v19, v81, v85
v_min3_u32 v18, v18, v89, v67
v_max3_u32 v19, v19, v89, v67
v_min3_u32 v18, v18, v71, v75
v_max3_u32 v19, v19, v71, v75
v_min3_u32 v18, v18, v79, v83
v_max3_u32 v19, v19, v79, v83
v_min3_u32 v18, v18, v87, v91
v_max3_u32 v19, v19, v87, v91
v_cmp_ne_u32 vcc, s60, v18
v_cmp_ne_u32 s[62:63], s60, v19
s_or_b64 vcc, vcc, s[62:63]
s_cbranch_vccnz L_creh
L_cokh:
s_mov_b32 s62, 0x01000100
v_perm_b32 v32, v56, v56, s62
v_mov_b32 v33, 0
v_mov_b32 v35, 0
v_mov_b32 v34, v32
v_perm_b32 v36, v58, v58, s62
v_mov_b32 v37, 0
v_mov_b32 v39, 0
v_mov_b32 v38, v36
v_perm_b32 v40, v60, v60, s62
v_mov_b32 v41, 0
v_mov_b32 v43, 0
v_mov_b32 v42, v40
v_perm_b32 v44, v62, v62, s62
v_mov_b32 v45, 0
v_mov_b32 v47, 0
v_mov_b32 v46, v44
s_nop 1
v_mfma_f32_16x16x32_bf16 v[128:131], v[64:67], v[32:35], v[128:131]
v_mfma_f32_16x16x32_bf16 v[132:135], v[64:67], v[36:39], v[132:135]
v_mfma_f32_16x16x32_bf16 v[136:139], v[64:67], v[40:43], v[136:139]
v_mfma_f32_16x16x32_bf16 v[140:143], v[64:67], v[44:47], v[140:143]
v_mfma_f32_16x16x32_bf16 v[144:147], v[68:71], v[32:35], v[144:147]
v_mfma_f32_16x16x32_bf16 v[148:151], v[68:71], v[36:39], v[148:151]
v_mfma_f32_16x16x32_bf16 v[152:155], v[68:71], v[40:43], v[152:155]
v_mfma_f32_16x16x32_bf16 v[156:159], v[68:71], v[44:47], v[156:159]
v_mfma_f32_16x16x32_bf16 v[160:163], v[72:75], v[32:35], v[160:163]
v_mfma_f32_16x16x32_bf16 v[164:167], v[72:75], v[36:39], v[164:167]
v_mfma_f32_16x16x32_bf16 v[168:171], v[72:75], v[40:43], v[168:171]
v_mfma_f32_16x16x32_bf16 v[172:175], v[72:75], v[44:47], v[172:175]
v_mfma_f32_16x16x32_bf16 v[176:179], v[76:79], v[32:35], v[176:179]
v_mfma_f32_16x16x32_bf16 v[180:183], v[76:79], v[36:39], v[180:183]
v_mfma_f32_16x16x32_bf16 v[184:187], v[76:79], v[40:43], v[184:187]
v_mfma_f32_16x16x32_bf16 v[188:191], v[76:79], v[44:47], v[188:191]
v_mfma_f32_16x16x32_bf16 v[192:195], v[80:83], v[32:35], v[192:195]
v_mfma_f32_16x16x32_bf16 v[196:199], v[80:83], v[36:39], v[196:199]
v_mfma_f32_16x16x32_bf16 v[200:203], v[80:83], v[40:43], v[200:203]
v_mfma_f32_16x16x32_bf16 v[204:207], v[80:83], v[44:47], v[204:207]
v_mfma_f32_16x16x32_bf16 v[208:211], v[84:87], v[32:35], v[208:211]
v_mfma_f32_16x16x32_bf16 v[212:215], v[84:87], v[36:39], v[212:215]
v_mfma_f32_16x16x32_bf16 v[216:219], v[84:87], v[40:43], v[216:219]
v_mfma_f32_16x16x32_bf16 v[220:223], v[84:87], v[44:47], v[220:223]
v_mfma_f32_16x16x32_bf16 v[224:227], v[88:91], v[32:35], v[224:227]
v_mfma_f32_16x16x32_bf16 v[228:231], v[88:91], v[36:39], v[228:231]
v_mfma_f32_16x16x32_bf16 v[232:235], v[88:91], v[40:43], v[232:235]
v_mfma_f32_16x16x32_bf16 v[236:239], v[88:91], v[44:47], v[236:239]
s_lshl_b32 s62, s43, 1
s_add_u32 s62, s62, s41
s_lshl_b32 s63, s62, 3
s_add_u32 s63, s63, s44
s_lshl_b32 s63, s63, 1
s_add_u32 s63, s63, s42
s_mul_i32 s63, s63, 14336
s_add_u32 s63, s63, 1048576
v_cvt_pk_bf16_f32 v128, v128, v129
v_cvt_pk_bf16_f32 v129, v130, v131
v_cvt_pk_bf16_f32 v130, v144, v145
v_cvt_pk_bf16_f32 v131, v146, v147
v_pk_max_i16 v128, v128, 0
v_pk_max_i16 v129, v129, 0
v_pk_max_i16 v130, v130, 0
v_pk_max_i16 v131, v131, 0
buffer_store_dwordx4 v[128:131], v95, s[24:27], s63 offen offset:0 sc1
v_cvt_pk_bf16_f32 v132, v132, v133
v_cvt_pk_bf16_f32 v133, v134, v135
v_cvt_pk_bf16_f32 v134, v148, v149
v_cvt_pk_bf16_f32 v135, v150, v151
v_pk_max_i16 v132, v132, 0
v_pk_max_i16 v133, v133, 0
v_pk_max_i16 v134, v134, 0
v_pk_max_i16 v135, v135, 0
buffer_store_dwordx4 v[132:135], v95, s[24:27], s63 offen offset:1024 sc1
v_cvt_pk_bf16_f32 v136, v136, v137
v_cvt_pk_bf16_f32 v137, v138, v139
v_cvt_pk_bf16_f32 v138, v152, v153
v_cvt_pk_bf16_f32 v139, v154, v155
v_pk_max_i16 v136, v136, 0
v_pk_max_i16 v137, v137, 0
v_pk_max_i16 v138, v138, 0
v_pk_max_i16 v139, v139, 0
buffer_store_dwordx4 v[136:139], v95, s[24:27], s63 offen offset:2048 sc1
v_cvt_pk_bf16_f32 v140, v140, v141
v_cvt_pk_bf16_f32 v141, v142, v143
v_cvt_pk_bf16_f32 v142, v156, v157
v_cvt_pk_bf16_f32 v143, v158, v159
v_pk_max_i16 v140, v140, 0
v_pk_max_i16 v141, v141, 0
v_pk_max_i16 v142, v142, 0
v_pk_max_i16 v143, v143, 0
buffer_store_dwordx4 v[140:143], v95, s[24:27], s63 offen offset:3072 sc1
s_add_u32 s63, s63, 4096
v_cvt_pk_bf16_f32 v160, v160, v161
v_cvt_pk_bf16_f32 v161, v162, v163
v_cvt_pk_bf16_f32 v162, v176, v177
v_cvt_pk_bf16_f32 v163, v178, v179
v_pk_max_i16 v160, v160, 0
v_pk_max_i16 v161, v161, 0
v_pk_max_i16 v162, v162, 0
v_pk_max_i16 v163, v163, 0
buffer_store_dwordx4 v[160:163], v95, s[24:27], s63 offen offset:0 sc1
v_cvt_pk_bf16_f32 v164, v164, v165
v_cvt_pk_bf16_f32 v165, v166, v167
v_cvt_pk_bf16_f32 v166, v180, v181
v_cvt_pk_bf16_f32 v167, v182, v183
v_pk_max_i16 v164, v164, 0
v_pk_max_i16 v165, v165, 0
v_pk_max_i16 v166, v166, 0
v_pk_max_i16 v167, v167, 0
buffer_store_dwordx4 v[164:167], v95, s[24:27], s63 offen offset:1024 sc1
v_cvt_pk_bf16_f32 v168, v168, v169
v_cvt_pk_bf16_f32 v169, v170, v171
v_cvt_pk_bf16_f32 v170, v184, v185
v_cvt_pk_bf16_f32 v171, v186, v187
v_pk_max_i16 v168, v168, 0
v_pk_max_i16 v169, v169, 0
v_pk_max_i16 v170, v170, 0
v_pk_max_i16 v171, v171, 0
buffer_store_dwordx4 v[168:171], v95, s[24:27], s63 offen offset:2048 sc1
v_cvt_pk_bf16_f32 v172, v172, v173
v_cvt_pk_bf16_f32 v173, v174, v175
v_cvt_pk_bf16_f32 v174, v188, v189
v_cvt_pk_bf16_f32 v175, v190, v191
v_pk_max_i16 v172, v172, 0
v_pk_max_i16 v173, v173, 0
v_pk_max_i16 v174, v174, 0
v_pk_max_i16 v175, v175, 0
buffer_store_dwordx4 v[172:175], v95, s[24:27], s63 offen offset:3072 sc1
s_add_u32 s63, s63, 4096
v_cvt_pk_bf16_f32 v192, v192, v193
v_cvt_pk_bf16_f32 v193, v194, v195
v_cvt_pk_bf16_f32 v194, v208, v209
v_cvt_pk_bf16_f32 v195, v210, v211
v_pk_max_i16 v192, v192, 0
v_pk_max_i16 v193, v193, 0
v_pk_max_i16 v194, v194, 0
v_pk_max_i16 v195, v195, 0
buffer_store_dwordx4 v[192:195], v95, s[24:27], s63 offen offset:0 sc1
v_cvt_pk_bf16_f32 v196, v196, v197
v_cvt_pk_bf16_f32 v197, v198, v199
v_cvt_pk_bf16_f32 v198, v212, v213
v_cvt_pk_bf16_f32 v199, v214, v215
v_pk_max_i16 v196, v196, 0
v_pk_max_i16 v197, v197, 0
v_pk_max_i16 v198, v198, 0
v_pk_max_i16 v199, v199, 0
buffer_store_dwordx4 v[196:199], v95, s[24:27], s63 offen offset:1024 sc1
v_cvt_pk_bf16_f32 v200, v200, v201
v_cvt_pk_bf16_f32 v201, v202, v203
v_cvt_pk_bf16_f32 v202, v216, v217
v_cvt_pk_bf16_f32 v203, v218, v219
v_pk_max_i16 v200, v200, 0
v_pk_max_i16 v201, v201, 0
v_pk_max_i16 v202, v202, 0
v_pk_max_i16 v203, v203, 0
buffer_store_dwordx4 v[200:203], v95, s[24:27], s63 offen offset:2048 sc1
v_cvt_pk_bf16_f32 v204, v204, v205
v_cvt_pk_bf16_f32 v205, v206, v207
v_cvt_pk_bf16_f32 v206, v220, v221
v_cvt_pk_bf16_f32 v207, v222, v223
v_pk_max_i16 v204, v204, 0
v_pk_max_i16 v205, v205, 0
v_pk_max_i16 v206, v206, 0
v_pk_max_i16 v207, v207, 0
buffer_store_dwordx4 v[204:207], v95, s[24:27], s63 offen offset:3072 sc1
s_add_u32 s63, s63, 4096
v_cvt_pk_bf16_f32 v224, v224, v225
v_cvt_pk_bf16_f32 v225, v226, v227
v_cvt_pk_bf16_f32 v226, v228, v229
v_cvt_pk_bf16_f32 v227, v230, v231
v_pk_max_i16 v224, v224, 0
v_pk_max_i16 v225, v225, 0
v_pk_max_i16 v226, v226, 0
v_pk_max_i16 v227, v227, 0
buffer_store_dwordx4 v[224:227], v95, s[24:27], s63 offen offset:0 sc1
v_cvt_pk_bf16_f32 v232, v232, v233
v_cvt_pk_bf16_f32 v233, v234, v235
v_cvt_pk_bf16_f32 v234, v236, v237
v_cvt_pk_bf16_f32 v235, v238, v239
v_pk_max_i16 v232, v232, 0
v_pk_max_i16 v233, v233, 0
v_pk_max_i16 v234, v234, 0
v_pk_max_i16 v235, v235, 0
buffer_store_dwordx4 v[232:235], v95, s[24:27], s63 offen offset:1024 sc1
s_waitcnt vmcnt(14)
ds_read_b64_tr_b16 a[160:161], v4 offset:0
ds_read_b64_tr_b16 a[162:163], v4 offset:2048
ds_read_b64_tr_b16 a[164:165], v5 offset:0
ds_read_b64_tr_b16 a[166:167], v5 offset:2048
ds_read_b64_tr_b16 a[168:169], v6 offset:0
ds_read_b64_tr_b16 a[170:171], v6 offset:2048
ds_read_b64_tr_b16 a[172:173], v7 offset:0
ds_read_b64_tr_b16 a[174:175], v7 offset:2048
ds_read_b64_tr_b16 a[176:177], v4 offset:4096
ds_read_b64_tr_b16 a[178:179], v4 offset:6144
ds_read_b64_tr_b16 a[180:181], v5 offset:4096
ds_read_b64_tr_b16 a[182:183], v5 offset:6144
ds_read_b64_tr_b16 a[184:185], v6 offset:4096
ds_read_b64_tr_b16 a[186:187], v6 offset:6144
ds_read_b64_tr_b16 a[188:189], v7 offset:4096
ds_read_b64_tr_b16 a[190:191], v7 offset:6144
ds_read_b64_tr_b16 a[192:193], v4 offset:8192
ds_read_b64_tr_b16 a[194:195], v4 offset:10240
ds_read_b64_tr_b16 a[196:197], v5 offset:8192
ds_read_b64_tr_b16 a[198:199], v5 offset:10240
ds_read_b64_tr_b16 a[200:201], v6 offset:8192
ds_read_b64_tr_b16 a[202:203], v6 offset:10240
ds_read_b64_tr_b16 a[204:205], v7 offset:8192
ds_read_b64_tr_b16 a[206:207], v7 offset:10240
ds_read_b64_tr_b16 a[208:209], v8 offset:0
ds_read_b64_tr_b16 a[210:211], v8 offset:2048
ds_read_b64_tr_b16 a[212:213], v9 offset:0
ds_read_b64_tr_b16 a[214:215], v9 offset:2048
ds_read_b64_tr_b16 a[216:217], v10 offset:0
ds_read_b64_tr_b16 a[218:219], v10 offset:2048
ds_read_b64_tr_b16 a[220:221], v11 offset:0
ds_read_b64_tr_b16 a[222:223], v11 offset:2048
ds_read_b64_tr_b16 a[224:225], v8 offset:4096
ds_read_b64_tr_b16 a[226:227], v8 offset:6144
ds_read_b64_tr_b16 a[228:229], v9 offset:4096
ds_read_b64_tr_b16 a[230:231], v9 offset:6144
ds_read_b64_tr_b16 a[232:233], v10 offset:4096
ds_read_b64_tr_b16 a[234:235], v10 offset:6144
ds_read_b64_tr_b16 a[236:237], v11 offset:4096
ds_read_b64_tr_b16 a[238:239], v11 offset:6144
ds_read_b64_tr_b16 a[240:241], v8 offset:8192
ds_read_b64_tr_b16 a[242:243], v8 offset:10240
ds_read_b64_tr_b16 a[244:245], v9 offset:8192
ds_read_b64_tr_b16 a[246:247], v9 offset:10240
ds_read_b64_tr_b16 a[248:249], v10 offset:8192
ds_read_b64_tr_b16 a[250:251], v10 offset:10240
ds_read_b64_tr_b16 a[252:253], v11 offset:8192
ds_read_b64_tr_b16 a[254:255], v11 offset:10240
s_lshl_b32 s63, s62, 2
s_lshr_b32 s64, s44, 1
s_add_u32 s63, s63, s64
s_lshl_b32 s63, s63, 7
s_and_b32 s64, s44, 1
s_lshl_b32 s64, s64, 1
s_add_u32 s64, s64, s42
s_lshl_b32 s64, s64, 2
s_add_u32 s63, s63, s64
s_add_u32 s63, s63, 327680
s_waitcnt vmcnt(0)
s_mov_b64 exec, 1
v_mov_b32 v17, s60
v_mov_b32 v16, 0
buffer_store_dword v17, v16, s[24:27], s63 offen sc1
s_mov_b64 exec, -1
s_branch L_p2
L_qkv:
s_mov_b32 s20, s6
s_mov_b32 s21, s7
s_mov_b32 s22, 0x180000
s_mov_b32 s23, 0x20000
s_lshl_b32 s59, s44, 7
s_mul_i32 s54, s40, 6144
s_add_u32 s54, s54, 16384
v_bfe_u32 v10, v1, 4, 1
v_lshlrev_b32 v10, 1, v10
v_xor_b32 v10, v5, v10
v_lshlrev_b32 v10, 4, v10
v_mul_u32_u24 v11, 3072, v4
s_mul_i32 s64, s40, 49152
v_add_u32 v11, s64, v11
v_add_u32 v104, v11, v10
v_mov_b32 v105, v104
v_mov_b32 v106, v104
v_xor_b32 v10, 64, v10
v_add_u32 v12, v11, v10
v_add_u32 v107, 21504, v12
v_add_u32 v108, 25600, v12
v_mov_b32 v109, v108
s_lshl_b32 s50, s48, 7
s_add_u32 s50, s50, s58
s_mul_i32 s51, s48, 196608
s_add_u32 s51, s51, s59
s_add_u32 s48, s48, 1
s_and_b32 s48, s48, 7
s_add_u32 m0, s54, 0
s_nop 0
buffer_load_dwordx4 v104, s[20:23], s51 offen offset:0 lds
buffer_load_dwordx4 v105, s[20:23], s51 offen offset:1024 lds
buffer_load_dwordx4 v106, s[20:23], s51 offen offset:2048 lds
buffer_load_dwordx4 v107, s[20:23], s51 offen offset:3072 lds
s_add_u32 m0, s54, 4096
s_nop 0
buffer_load_dwordx4 v108, s[20:23], s51 offen offset:0 lds
buffer_load_dwordx4 v109, s[20:23], s51 offen offset:1024 lds
global_load_dword v2, v3, s[66:67]
s_lshl_b32 s64, s41, 13
v_and_b32 v10, 15, v1
v_lshrrev_b32 v11, 4, v1
v_xor_b32 v12, v11, v5
v_lshlrev_b32 v12, 4, v12
v_lshl_add_u32 v12, v10, 7, v12
v_add_u32 v116, s64, v12
v_xor_b32 v117, 64, v116
v_bfe_u32 v12, v1, 2, 2
v_and_b32 v13, 3, v1
v_lshlrev_b32 v13, 3, v13
v_and_b32 v14, 1, v11
v_lshlrev_b32 v14, 1, v14
v_lshrrev_b32 v15, 1, v12
v_or_b32 v14, v14, v15
v_mul_u32_u24 v15, 3072, v11
v_lshl_add_u32 v15, v12, 7, v15
v_add_u32 v15, v15, v13
v_add_u32 v15, 16384, v15
s_lshl_b32 s65, s42, 1
s_add_u32 s65, s65, 0
v_xor_b32 v16, s65, v14
v_lshl_add_u32 v118, v16, 5, v15
s_lshl_b32 s65, s42, 1
s_add_u32 s65, s65, 1
v_xor_b32 v16, s65, v14
v_lshl_add_u32 v119, v16, 5, v15
v_add_u32 v125, 49152, v116
v_add_u32 v126, 49152, v117
v_add_u32 v127, 49152, v118
v_add_u32 v240, 49152, v119
v_add_u32 v246, 98304, v116
v_add_u32 v247, 98304, v117
v_add_u32 v248, 98304, v118
v_add_u32 v249, 98304, v119
v_bfe_u32 v14, v1, 4, 2
v_lshlrev_b32 v14, 1, v14
v_xor_b32 v14, v5, v14
v_lshlrev_b32 v14, 4, v14
v_lshl_add_u32 v112, v4, 10, v14
v_add_u32 v113, 7168, v112
v_add_u32 v114, 14336, v112
v_add_u32 v115, 21504, v112
s_mov_b32 s72, s14
s_mov_b32 s73, s15
s_mov_b32 s74, 0x1c0000
s_mov_b32 s75, 0x20000
s_mov_b32 s76, s8
s_mov_b32 s77, s9
s_mov_b32 s78, 0x80000
s_mov_b32 s79, 0x20000
s_lshl_b32 s64, s47, 7
s_mul_i32 s70, s40, 458752
s_add_u32 s70, s70, s64
s_lshl_b32 s71, s40, 17
s_add_u32 s71, s71, s64
s_mul_i32 s55, s40, 12288
s_add_u32 s3, s46, s47
s_add_u32 s64, s3, 0
s_and_b32 s64, s64, 3
s_mul_i32 s64, s64, 114688
s_add_u32 s12, s64, s70
s_add_u32 s64, s3, 1
s_and_b32 s64, s64, 3
s_mul_i32 s64, s64, 114688
s_add_u32 s13, s64, s70
s_add_u32 s64, s3, 2
s_and_b32 s64, s64, 3
s_mul_i32 s64, s64, 114688
s_add_u32 s14, s64, s70
s_add_u32 s64, s3, 3
s_and_b32 s64, s64, 3
s_mul_i32 s64, s64, 114688
s_add_u32 s15, s64, s70
v_lshl_add_u32 v14, v11, 2, v12
v_bfe_u32 v15, v14, 1, 2
v_lshl_add_u32 v14, v14, 7, v13
v_add_u32 v14, s55, v14
v_lshlrev_b32 v94, 3, v10
v_lshlrev_b32 v95, 4, v1
v_and_b32 v99, 0x1ff, v95
v_lshlrev_b32 v96, 4, v10
v_lshlrev_b32 v97, 3, v7
v_xor_b32 v16, 0, v15
v_lshl_add_u32 v4, v16, 5, v14
v_xor_b32 v16, 1, v15
v_lshl_add_u32 v5, v16, 5, v14
v_xor_b32 v16, 2, v15
v_lshl_add_u32 v6, v16, 5, v14
v_xor_b32 v16, 3, v15
v_lshl_add_u32 v7, v16, 5, v14
v_add_u32 v8, 49152, v4
v_add_u32 v9, 49152, v5
v_add_u32 v10, 49152, v6
v_add_u32 v11, 49152, v7
v_add_u32 v12, 98304, v4
v_add_u32 v13, 98304, v5
v_add_u32 v14, 98304, v6
v_add_u32 v15, 98304, v7
v_mov_b32 v28, 0x3f803f80
v_mov_b32 v29, 0x3f803f80
v_mov_b32 v30, 0x3f803f80
v_mov_b32 v31, 0x3f803f80
s_lshl_b32 s56, s43, 10
s_lshl_b32 s64, s41, 9
s_add_u32 s56, s56, s64
s_lshl_b32 s57, s44, 1
s_add_u32 s57, s57, s42
s_mul_i32 s57, s57, 6144
s_add_u32 s57, s57, 180224
s_lshr_b32 s64, s2, 3
s_lshl_b32 s64, s64, 2
s_add_u32 s64, s64, s40
v_min_u32 v98, 15, v1
v_lshlrev_b32 v98, 7, v98
s_lshl_b32 s65, s64, 12
v_add_u32 v26, s65, v98
s_mul_i32 s65, s64, 14336
v_add_u32 v98, s65, v98
s_waitcnt vmcnt(11)
v_lshlrev_b32 v40, 16, v32
v_and_b32 v41, 0xffff0000, v32
v_lshlrev_b32 v42, 16, v33
v_and_b32 v43, 0xffff0000, v33
v_lshlrev_b32 v44, 16, v34
v_and_b32 v45, 0xffff0000, v34
v_lshlrev_b32 v46, 16, v35
v_and_b32 v47, 0xffff0000, v35
v_lshlrev_b32 v48, 16, v36
v_and_b32 v49, 0xffff0000, v36
v_lshlrev_b32 v50, 16, v37
v_and_b32 v51, 0xffff0000, v37
v_lshlrev_b32 v52, 16, v38
v_and_b32 v53, 0xffff0000, v38
v_lshlrev_b32 v54, 16, v39
v_and_b32 v55, 0xffff0000, v39
v_pk_add_f32 v[18:19], v[40:41], v[42:43]
v_pk_add_f32 v[20:21], v[44:45], v[46:47]
v_pk_add_f32 v[22:23], v[48:49], v[50:51]
v_pk_add_f32 v[24:25], v[52:53], v[54:55]
v_pk_add_f32 v[18:19], v[18:19], v[20:21]
v_pk_add_f32 v[22:23], v[22:23], v[24:25]
v_pk_add_f32 v[18:19], v[18:19], v[22:23]
v_add_f32 v18, v18, v19
s_nop 1
v_add_f32_dpp v18, v18, v18 row_ror:8 row_mask:0xf bank_mask:0xf
s_nop 1
v_add_f32_dpp v18, v18, v18 row_ror:4 row_mask:0xf bank_mask:0xf
s_nop 1
v_add_f32_dpp v18, v18, v18 row_ror:2 row_mask:0xf bank_mask:0xf
s_nop 1
v_add_f32_dpp v18, v18, v18 row_ror:1 row_mask:0xf bank_mask:0xf
s_nop 1
v_mov_b32 v19, v18
s_nop 1
v_permlane16_swap_b32 v18, v19
s_nop 1
v_add_f32 v18, v18, v19
v_mul_f32 v20, 0xbb000000, v18
v_mov_b32 v21, v20
v_pk_add_f32 v[40:41], v[40:41], v[20:21]
v_pk_add_f32 v[42:43], v[42:43], v[20:21]
v_pk_add_f32 v[44:45], v[44:45], v[20:21]
v_pk_add_f32 v[46:47], v[46:47], v[20:21]
v_pk_add_f32 v[48:49], v[48:49], v[20:21]
v_pk_add_f32 v[50:51], v[50:51], v[20:21]
v_pk_add_f32 v[52:53], v[52:53], v[20:21]
v_pk_add_f32 v[54:55], v[54:55], v[20:21]
v_pk_mul_f32 v[22:23], v[40:41], v[40:41]
v_pk_mul_f32 v[24:25], v[42:43], v[42:43]
v_pk_fma_f32 v[22:23], v[44:45], v[44:45], v[22:23]
v_pk_fma_f32 v[24:25], v[46:47], v[46:47], v[24:25]
v_pk_fma_f32 v[22:23], v[48:49], v[48:49], v[22:23]
v_pk_fma_f32 v[24:25], v[50:51], v[50:51], v[24:25]
v_pk_fma_f32 v[22:23], v[52:53], v[52:53], v[22:23]
v_pk_fma_f32 v[24:25], v[54:55], v[54:55], v[24:25]
v_pk_add_f32 v[22:23], v[22:23], v[24:25]
v_add_f32 v22, v22, v23
s_nop 1
v_add_f32_dpp v22, v22, v22 row_ror:8 row_mask:0xf bank_mask:0xf
s_nop 1
v_add_f32_dpp v22, v22, v22 row_ror:4 row_mask:0xf bank_mask:0xf
s_nop 1
v_add_f32_dpp v22, v22, v22 row_ror:2 row_mask:0xf bank_mask:0xf
s_nop 1
v_add_f32_dpp v22, v22, v22 row_ror:1 row_mask:0xf bank_mask:0xf
s_nop 1
v_mov_b32 v23, v22
s_nop 1
v_permlane16_swap_b32 v22, v23
s_nop 1
v_add_f32 v22, v22, v23
v_mul_f32 v22, 0x3b000000, v22
v_cvt_pk_bf16_f32 v22, v22, v22
v_and_b32 v22, 0xffff0000, v22
v_add_f32 v22, 0x3727c5ac, v22
v_cvt_pk_bf16_f32 v22, v22, v22
v_and_b32 v22, 0xffff0000, v22
v_sqrt_f32 v22, v22
s_nop 0
v_cvt_pk_bf16_f32 v92, v20, v22
s_lshl_b32 s50, s48, 7
s_add_u32 s50, s50, s58
s_mul_i32 s51, s48, 196608
s_add_u32 s51, s51, s59
s_add_u32 s48, s48, 1
s_and_b32 s48, s48, 7
s_add_u32 m0, s53, 49152
s_nop 0
buffer_load_dwordx4 v100, s[16:19], s50 offen offset:0 lds
buffer_load_dwordx4 v101, s[16:19], s50 offen offset:1024 lds
buffer_load_dwordx4 v102, s[16:19], s50 offen offset:2048 lds
buffer_load_dwordx4 v103, s[16:19], s50 offen offset:3072 lds
s_add_u32 m0, s54, 49152
s_nop 0
buffer_load_dwordx4 v104, s[20:23], s51 offen offset:0 lds
buffer_load_dwordx4 v105, s[20:23], s51 offen offset:1024 lds
buffer_load_dwordx4 v106, s[20:23], s51 offen offset:2048 lds
buffer_load_dwordx4 v107, s[20:23], s51 offen offset:3072 lds
s_add_u32 m0, s54, 53248
s_nop 0
buffer_load_dwordx4 v108, s[20:23], s51 offen offset:0 lds
buffer_load_dwordx4 v109, s[20:23], s51 offen offset:1024 lds
s_lshl_b32 s64, s2, 2
s_add_u32 s64, s64, s40
s_mul_i32 s65, s64, 1792
s_lshl_b32 s64, s64, 9
v_min_u32 v16, 13, v1
v_lshlrev_b32 v16, 7, v16
v_and_b32 v17, 3, v1
v_lshlrev_b32 v17, 7, v17
buffer_load_dword v27, v16, s[72:75], s65 offen
buffer_load_dword v27, v17, s[76:79], s64 offen
s_waitcnt vmcnt(13)
s_barrier
ds_read_b64_tr_b16 a[16:17], v118 offset:0
ds_read_b64_tr_b16 a[18:19], v118 offset:512
ds_read_b128 a[0:3], v116 offset:0
ds_read_b128 a[4:7], v116 offset:2048
ds_read_b128 a[8:11], v116 offset:4096
ds_read_b128 a[12:15], v116 offset:6144
ds_read_b64_tr_b16 a[20:21], v119 offset:0
ds_read_b64_tr_b16 a[22:23], v119 offset:512
ds_read_b64_tr_b16 a[24:25], v118 offset:1024
ds_read_b64_tr_b16 a[26:27], v118 offset:1536
ds_read_b64_tr_b16 a[28:29], v119 offset:1024
ds_read_b64_tr_b16 a[30:31], v119 offset:1536
ds_read_b64_tr_b16 a[32:33], v118 offset:2048
ds_read_b64_tr_b16 a[34:35], v118 offset:2560
ds_read_b64_tr_b16 a[36:37], v119 offset:2048
ds_read_b64_tr_b16 a[38:39], v119 offset:2560
s_waitcnt lgkmcnt(0)
v_mfma_f32_16x16x32_bf16 v[128:131], a[16:19], a[0:3], 0
ds_read_b64_tr_b16 a[60:61], v118 offset:12288
s_lshl_b32 s50, s48, 7
s_add_u32 s50, s50, s58
s_mul_i32 s51, s48, 196608
s_add_u32 s51, s51, s59
s_add_u32 s48, s48, 1
s_and_b32 s48, s48, 7
s_add_u32 m0, s53, 98304
v_mfma_f32_16x16x32_bf16 v[132:135], a[16:19], a[4:7], 0
ds_read_b64_tr_b16 a[62:63], v118 offset:12800
buffer_load_dwordx4 v100, s[16:19], s50 offen offset:0 lds
v_mfma_f32_16x16x32_bf16 v[136:139], a[16:19], a[8:11], 0
ds_read_b128 a[44:47], v117 offset:0
v_mfma_f32_16x16x32_bf16 v[140:143], a[16:19], a[12:15], 0
ds_read_b128 a[48:51], v117 offset:2048
buffer_load_dwordx4 v101, s[16:19], s50 offen offset:1024 lds
v_mfma_f32_16x16x32_bf16 v[144:147], a[20:23], a[0:3], 0
ds_read_b128 a[52:55], v117 offset:4096
v_mfma_f32_16x16x32_bf16 v[148:151], a[20:23], a[4:7], 0
ds_read_b128 a[56:59], v117 offset:6144
buffer_load_dwordx4 v102, s[16:19], s50 offen offset:2048 lds
v_mfma_f32_16x16x32_bf16 v[152:155], a[20:23], a[8:11], 0
ds_read_b64_tr_b16 a[64:65], v119 offset:12288
v_mfma_f32_16x16x32_bf16 v[156:159], a[20:23], a[12:15], 0
ds_read_b64_tr_b16 a[66:67], v119 offset:12800
buffer_load_dwordx4 v103, s[16:19], s50 offen offset:3072 lds
v_mfma_f32_16x16x32_bf16 v[160:163], a[0:3], a[24:27], 0
ds_read_b64_tr_b16 a[68:69], v118 offset:13312
s_add_u32 m0, s54, 98304
v_mfma_f32_16x16x32_bf16 v[164:167], a[4:7], a[24:27], 0
ds_read_b64_tr_b16 a[70:71], v118 offset:13824
buffer_load_dwordx4 v104, s[20:23], s51 offen offset:0 lds
v_mfma_f32_16x16x32_bf16 v[168:171], a[8:11], a[24:27], 0
ds_read_b64_tr_b16 a[72:73], v119 offset:13312
v_mfma_f32_16x16x32_bf16 v[172:175], a[12:15], a[24:27], 0
ds_read_b64_tr_b16 a[74:75], v119 offset:13824
buffer_load_dwordx4 v105, s[20:23], s51 offen offset:1024 lds
v_mfma_f32_16x16x32_bf16 v[176:179], a[0:3], a[28:31], 0
ds_read_b64_tr_b16 a[76:77], v118 offset:14336
v_mfma_f32_16x16x32_bf16 v[180:183], a[4:7], a[28:31], 0
ds_read_b64_tr_b16 a[78:79], v118 offset:14848
buffer_load_dwordx4 v106, s[20:23], s51 offen offset:2048 lds
v_mfma_f32_16x16x32_bf16 v[184:187], a[8:11], a[28:31], 0
ds_read_b64_tr_b16 a[80:81], v119 offset:14336
v_mfma_f32_16x16x32_bf16 v[188:191], a[12:15], a[28:31], 0
ds_read_b64_tr_b16 a[82:83], v119 offset:14848
buffer_load_dwordx4 v107, s[20:23], s51 offen offset:3072 lds
v_mfma_f32_16x16x32_bf16 v[192:195], a[0:3], a[32:35], 0
s_add_u32 m0, s54, 102400
v_mfma_f32_16x16x32_bf16 v[196:199], a[4:7], a[32:35], 0
buffer_load_dwordx4 v108, s[20:23], s51 offen offset:0 lds
v_mfma_f32_16x16x32_bf16 v[200:203], a[8:11], a[32:35], 0
v_mfma_f32_16x16x32_bf16 v[204:207], a[12:15], a[32:35], 0
buffer_load_dwordx4 v109, s[20:23], s51 offen offset:1024 lds
v_mfma_f32_16x16x32_bf16 v[208:211], a[0:3], a[36:39], 0
v_mov_b32 v16, 0
v_mfma_f32_16x16x32_bf16 v[212:215], a[4:7], a[36:39], 0
buffer_load_dword v93, v16, s[28:31], 0 offen sc1
v_mfma_f32_16x16x32_bf16 v[216:219], a[8:11], a[36:39], 0
v_mfma_f32_16x16x32_bf16 v[220:223], a[12:15], a[36:39], 0
s_cmp_lt_u32 s43, 4
s_cbranch_scc0 L_csq0
s_cmp_eq_u32 s41, 0
s_cbranch_scc0 L_csq0h
v_mfma_f32_16x16x32_bf16 v[64:67], v[28:31], a[16:19], 0
v_mfma_f32_16x16x32_bf16 v[68:71], v[28:31], a[20:23], 0
v_mfma_f32_16x16x32_bf16 v[72:75], v[28:31], a[24:27], 0
s_branch L_csq0
L_csq0h:
v_mfma_f32_16x16x32_bf16 v[64:67], v[28:31], a[28:31], 0
v_mfma_f32_16x16x32_bf16 v[68:71], v[28:31], a[32:35], 0
v_mfma_f32_16x16x32_bf16 v[72:75], v[28:31], a[36:39], 0
L_csq0:
s_waitcnt vmcnt(13) lgkmcnt(0)
s_barrier
v_mfma_f32_16x16x32_bf16 v[128:131], a[60:63], a[44:47], v[128:131]
ds_read_b64_tr_b16 a[16:17], v127 offset:0
v_mfma_f32_16x16x32_bf16 v[132:135], a[60:63], a[48:51], v[132:135]
ds_read_b64_tr_b16 a[18:19], v127 offset:512
v_mfma_f32_16x16x32_bf16 v[136:139], a[60:63], a[52:55], v[136:139]
ds_read_b128 a[0:3], v125 offset:0
s_lshl_b32 s50, s48, 7
v_mfma_f32_16x16x32_bf16 v[140:143], a[60:63], a[56:59], v[140:143]
ds_read_b128 a[4:7], v125 offset:2048
s_add_u32 s50, s50, s58
v_mfma_f32_16x16x32_bf16 v[144:147], a[64:67], a[44:47], v[144:147]
ds_read_b128 a[8:11], v125 offset:4096
s_mul_i32 s51, s48, 196608
v_mfma_f32_16x16x32_bf16 v[148:151], a[64:67], a[48:51], v[148:151]
ds_read_b128 a[12:15], v125 offset:6144
s_add_u32 s51, s51, s59
v_mfma_f32_16x16x32_bf16 v[152:155], a[64:67], a[52:55], v[152:155]
ds_read_b64_tr_b16 a[20:21], v240 offset:0
s_add_u32 s48, s48, 1
v_mfma_f32_16x16x32_bf16 v[156:159], a[64:67], a[56:59], v[156:159]
ds_read_b64_tr_b16 a[22:23], v240 offset:512
s_and_b32 s48, s48, 7
v_mfma_f32_16x16x32_bf16 v[160:163], a[44:47], a[68:71], v[160:163]
ds_read_b64_tr_b16 a[24:25], v127 offset:1024
s_add_u32 m0, s53, 0
v_mfma_f32_16x16x32_bf16 v[164:167], a[48:51], a[68:71], v[164:167]
ds_read_b64_tr_b16 a[26:27], v127 offset:1536
buffer_load_dwordx4 v100, s[16:19], s50 offen offset:0 lds
v_mfma_f32_16x16x32_bf16 v[168:171], a[52:55], a[68:71], v[168:171]
ds_read_b64_tr_b16 a[28:29], v240 offset:1024
v_mfma_f32_16x16x32_bf16 v[172:175], a[56:59], a[68:71], v[172:175]
ds_read_b64_tr_b16 a[30:31], v240 offset:1536
v_mfma_f32_16x16x32_bf16 v[176:179], a[44:47], a[72:75], v[176:179]
ds_read_b64_tr_b16 a[32:33], v127 offset:2048
buffer_load_dwordx4 v101, s[16:19], s50 offen offset:1024 lds
v_mfma_f32_16x16x32_bf16 v[180:183], a[48:51], a[72:75], v[180:183]
ds_read_b64_tr_b16 a[34:35], v127 offset:2560
v_mfma_f32_16x16x32_bf16 v[184:187], a[52:55], a[72:75], v[184:187]
ds_read_b64_tr_b16 a[36:37], v240 offset:2048
v_mfma_f32_16x16x32_bf16 v[188:191], a[56:59], a[72:75], v[188:191]
ds_read_b64_tr_b16 a[38:39], v240 offset:2560
buffer_load_dwordx4 v102, s[16:19], s50 offen offset:2048 lds
v_mfma_f32_16x16x32_bf16 v[192:195], a[44:47], a[76:79], v[192:195]
v_mfma_f32_16x16x32_bf16 v[196:199], a[48:51], a[76:79], v[196:199]
v_mfma_f32_16x16x32_bf16 v[200:203], a[52:55], a[76:79], v[200:203]
buffer_load_dwordx4 v103, s[16:19], s50 offen offset:3072 lds
v_mfma_f32_16x16x32_bf16 v[204:207], a[56:59], a[76:79], v[204:207]
v_mfma_f32_16x16x32_bf16 v[208:211], a[44:47], a[80:83], v[208:211]
s_add_u32 m0, s54, 0
v_mfma_f32_16x16x32_bf16 v[212:215], a[48:51], a[80:83], v[212:215]
buffer_load_dwordx4 v104, s[20:23], s51 offen offset:0 lds
v_mfma_f32_16x16x32_bf16 v[216:219], a[52:55], a[80:83], v[216:219]
v_mfma_f32_16x16x32_bf16 v[220:223], a[56:59], a[80:83], v[220:223]
s_cmp_lt_u32 s43, 4
s_cbranch_scc0 L_csq1
s_cmp_eq_u32 s41, 0
s_cbranch_scc0 L_csq1h
v_mfma_f32_16x16x32_bf16 v[64:67], v[28:31], a[60:63], v[64:67]
v_mfma_f32_16x16x32_bf16 v[68:71], v[28:31], a[64:67], v[68:71]
v_mfma_f32_16x16x32_bf16 v[72:75], v[28:31], a[68:71], v[72:75]
s_branch L_csq1
L_csq1h:
v_mfma_f32_16x16x32_bf16 v[64:67], v[28:31], a[72:75], v[64:67]
v_mfma_f32_16x16x32_bf16 v[68:71], v[28:31], a[76:79], v[68:71]
v_mfma_f32_16x16x32_bf16 v[72:75], v[28:31], a[80:83], v[72:75]
L_csq1:
s_waitcnt lgkmcnt(0)
v_mfma_f32_16x16x32_bf16 v[128:131], a[16:19], a[0:3], v[128:131]
ds_read_b64_tr_b16 a[60:61], v127 offset:12288
v_mfma_f32_16x16x32_bf16 v[132:135], a[16:19], a[4:7], v[132:135]
ds_read_b64_tr_b16 a[62:63], v127 offset:12800
v_mfma_f32_16x16x32_bf16 v[136:139], a[16:19], a[8:11], v[136:139]
ds_read_b128 a[44:47], v126 offset:0
v_mfma_f32_16x16x32_bf16 v[140:143], a[16:19], a[12:15], v[140:143]
ds_read_b128 a[48:51], v126 offset:2048
v_mfma_f32_16x16x32_bf16 v[144:147], a[20:23], a[0:3], v[144:147]
ds_read_b128 a[52:55], v126 offset:4096
v_mfma_f32_16x16x32_bf16 v[148:151], a[20:23], a[4:7], v[148:151]
ds_read_b128 a[56:59], v126 offset:6144
v_mfma_f32_16x16x32_bf16 v[152:155], a[20:23], a[8:11], v[152:155]
ds_read_b64_tr_b16 a[64:65], v240 offset:12288
v_mfma_f32_16x16x32_bf16 v[156:159], a[20:23], a[12:15], v[156:159]
ds_read_b64_tr_b16 a[66:67], v240 offset:12800
v_mfma_f32_16x16x32_bf16 v[160:163], a[0:3], a[24:27], v[160:163]
ds_read_b64_tr_b16 a[68:69], v127 offset:13312
v_mfma_f32_16x16x32_bf16 v[164:167], a[4:7], a[24:27], v[164:167]
ds_read_b64_tr_b16 a[70:71], v127 offset:13824
buffer_load_dwordx4 v105, s[20:23], s51 offen offset:1024 lds
v_mfma_f32_16x16x32_bf16 v[168:171], a[8:11], a[24:27], v[168:171]
ds_read_b64_tr_b16 a[72:73], v240 offset:13312
v_mfma_f32_16x16x32_bf16 v[172:175], a[12:15], a[24:27], v[172:175]
ds_read_b64_tr_b16 a[74:75], v240 offset:13824
v_mfma_f32_16x16x32_bf16 v[176:179], a[0:3], a[28:31], v[176:179]
ds_read_b64_tr_b16 a[76:77], v127 offset:14336
buffer_load_dwordx4 v106, s[20:23], s51 offen offset:2048 lds
v_mfma_f32_16x16x32_bf16 v[180:183], a[4:7], a[28:31], v[180:183]
ds_read_b64_tr_b16 a[78:79], v127 offset:14848
v_mfma_f32_16x16x32_bf16 v[184:187], a[8:11], a[28:31], v[184:187]
ds_read_b64_tr_b16 a[80:81], v240 offset:14336
v_mfma_f32_16x16x32_bf16 v[188:191], a[12:15], a[28:31], v[188:191]
ds_read_b64_tr_b16 a[82:83], v240 offset:14848
buffer_load_dwordx4 v107, s[20:23], s51 offen offset:3072 lds
v_mfma_f32_16x16x32_bf16 v[192:195], a[0:3], a[32:35], v[192:195]
v_mfma_f32_16x16x32_bf16 v[196:199], a[4:7], a[32:35], v[196:199]
s_add_u32 m0, s54, 4096
v_mfma_f32_16x16x32_bf16 v[200:203], a[8:11], a[32:35], v[200:203]
buffer_load_dwordx4 v108, s[20:23], s51 offen offset:0 lds
v_mfma_f32_16x16x32_bf16 v[204:207], a[12:15], a[32:35], v[204:207]
v_mfma_f32_16x16x32_bf16 v[208:211], a[0:3], a[36:39], v[208:211]
v_mfma_f32_16x16x32_bf16 v[212:215], a[4:7], a[36:39], v[212:215]
buffer_load_dwordx4 v109, s[20:23], s51 offen offset:1024 lds
v_mfma_f32_16x16x32_bf16 v[216:219], a[8:11], a[36:39], v[216:219]
v_mfma_f32_16x16x32_bf16 v[220:223], a[12:15], a[36:39], v[220:223]
s_cmp_lt_u32 s43, 4
s_cbranch_scc0 L_csq2
s_cmp_eq_u32 s41, 0
s_cbranch_scc0 L_csq2h
v_mfma_f32_16x16x32_bf16 v[64:67], v[28:31], a[16:19], v[64:67]
v_mfma_f32_16x16x32_bf16 v[68:71], v[28:31], a[20:23], v[68:71]
v_mfma_f32_16x16x32_bf16 v[72:75], v[28:31], a[24:27], v[72:75]
s_branch L_csq2
L_csq2h:
v_mfma_f32_16x16x32_bf16 v[64:67], v[28:31], a[28:31], v[64:67]
v_mfma_f32_16x16x32_bf16 v[68:71], v[28:31], a[32:35], v[68:71]
v_mfma_f32_16x16x32_bf16 v[72:75], v[28:31], a[36:39], v[72:75]
L_csq2:
s_waitcnt vmcnt(10) lgkmcnt(0)
s_barrier
v_readfirstlane_b32 s60, v93
s_mov_b32 s61, 0
s_cmp_eq_u32 s60, 0
s_cbranch_scc1 L_nspinq
L_nbackq:
v_mfma_f32_16x16x32_bf16 v[128:131], a[60:63], a[44:47], v[128:131]
ds_read_b64_tr_b16 a[16:17], v248 offset:0
v_mfma_f32_16x16x32_bf16 v[132:135], a[60:63], a[48:51], v[132:135]
ds_read_b64_tr_b16 a[18:19], v248 offset:512
v_mfma_f32_16x16x32_bf16 v[136:139], a[60:63], a[52:55], v[136:139]
ds_read_b128 a[0:3], v246 offset:0
s_lshl_b32 s50, s48, 7
v_mfma_f32_16x16x32_bf16 v[140:143], a[60:63], a[56:59], v[140:143]
ds_read_b128 a[4:7], v246 offset:2048
s_add_u32 s50, s50, s58
v_mfma_f32_16x16x32_bf16 v[144:147], a[64:67], a[44:47], v[144:147]
ds_read_b128 a[8:11], v246 offset:4096
s_mul_i32 s51, s48, 196608
v_mfma_f32_16x16x32_bf16 v[148:151], a[64:67], a[48:51], v[148:151]
ds_read_b128 a[12:15], v246 offset:6144
s_add_u32 s51, s51, s59
v_mfma_f32_16x16x32_bf16 v[152:155], a[64:67], a[52:55], v[152:155]
ds_read_b64_tr_b16 a[20:21], v249 offset:0
s_add_u32 s48, s48, 1
v_mfma_f32_16x16x32_bf16 v[156:159], a[64:67], a[56:59], v[156:159]
ds_read_b64_tr_b16 a[22:23], v249 offset:512
s_and_b32 s48, s48, 7
v_mfma_f32_16x16x32_bf16 v[160:163], a[44:47], a[68:71], v[160:163]
ds_read_b64_tr_b16 a[24:25], v248 offset:1024
s_add_u32 m0, s53, 49152
v_mfma_f32_16x16x32_bf16 v[164:167], a[48:51], a[68:71], v[164:167]
ds_read_b64_tr_b16 a[26:27], v248 offset:1536
buffer_load_dwordx4 v100, s[16:19], s50 offen offset:0 lds
v_mfma_f32_16x16x32_bf16 v[168:171], a[52:55], a[68:71], v[168:171]
ds_read_b64_tr_b16 a[28:29], v249 offset:1024
v_mfma_f32_16x16x32_bf16 v[172:175], a[56:59], a[68:71], v[172:175]
ds_read_b64_tr_b16 a[30:31], v249 offset:1536
v_mfma_f32_16x16x32_bf16 v[176:179], a[44:47], a[72:75], v[176:179]
ds_read_b64_tr_b16 a[32:33], v248 offset:2048
buffer_load_dwordx4 v101, s[16:19], s50 offen offset:1024 lds
v_mfma_f32_16x16x32_bf16 v[180:183], a[48:51], a[72:75], v[180:183]
ds_read_b64_tr_b16 a[34:35], v248 offset:2560
v_mfma_f32_16x16x32_bf16 v[184:187], a[52:55], a[72:75], v[184:187]
ds_read_b64_tr_b16 a[36:37], v249 offset:2048
v_mfma_f32_16x16x32_bf16 v[188:191], a[56:59], a[72:75], v[188:191]
ds_read_b64_tr_b16 a[38:39], v249 offset:2560
buffer_load_dwordx4 v102, s[16:19], s50 offen offset:2048 lds
v_mfma_f32_16x16x32_bf16 v[192:195], a[44:47], a[76:79], v[192:195]
v_mfma_f32_16x16x32_bf16 v[196:199], a[48:51], a[76:79], v[196:199]
v_mfma_f32_16x16x32_bf16 v[200:203], a[52:55], a[76:79], v[200:203]
buffer_load_dwordx4 v103, s[16:19], s50 offen offset:3072 lds
v_mfma_f32_16x16x32_bf16 v[204:207], a[56:59], a[76:79], v[204:207]
v_mfma_f32_16x16x32_bf16 v[208:211], a[44:47], a[80:83], v[208:211]
s_add_u32 m0, s54, 49152
v_mfma_f32_16x16x32_bf16 v[212:215], a[48:51], a[80:83], v[212:215]
buffer_load_dwordx4 v104, s[20:23], s51 offen offset:0 lds
v_mfma_f32_16x16x32_bf16 v[216:219], a[52:55], a[80:83], v[216:219]
v_mfma_f32_16x16x32_bf16 v[220:223], a[56:59], a[80:83], v[220:223]
s_cmp_lt_u32 s43, 4
s_cbranch_scc0 L_csq3
s_cmp_eq_u32 s41, 0
s_cbranch_scc0 L_csq3h
v_mfma_f32_16x16x32_bf16 v[64:67], v[28:31], a[60:63], v[64:67]
v_mfma_f32_16x16x32_bf16 v[68:71], v[28:31], a[64:67], v[68:71]
v_mfma_f32_16x16x32_bf16 v[72:75], v[28:31], a[68:71], v[72:75]
s_branch L_csq3
L_csq3h:
v_mfma_f32_16x16x32_bf16 v[64:67], v[28:31], a[72:75], v[64:67]
v_mfma_f32_16x16x32_bf16 v[68:71], v[28:31], a[76:79], v[68:71]
v_mfma_f32_16x16x32_bf16 v[72:75], v[28:31], a[80:83], v[72:75]
L_csq3:
s_waitcnt lgkmcnt(0)
v_mfma_f32_16x16x32_bf16 v[128:131], a[16:19], a[0:3], v[128:131]
ds_read_b64_tr_b16 a[60:61], v248 offset:12288
v_mfma_f32_16x16x32_bf16 v[132:135], a[16:19], a[4:7], v[132:135]
ds_read_b64_tr_b16 a[62:63], v248 offset:12800
v_mfma_f32_16x16x32_bf16 v[136:139], a[16:19], a[8:11], v[136:139]
ds_read_b128 a[44:47], v247 offset:0
v_mfma_f32_16x16x32_bf16 v[140:143], a[16:19], a[12:15], v[140:143]
ds_read_b128 a[48:51], v247 offset:2048
v_mfma_f32_16x16x32_bf16 v[144:147], a[20:23], a[0:3], v[144:147]
ds_read_b128 a[52:55], v247 offset:4096
v_mfma_f32_16x16x32_bf16 v[148:151], a[20:23], a[4:7], v[148:151]
ds_read_b128 a[56:59], v247 offset:6144
v_mfma_f32_16x16x32_bf16 v[152:155], a[20:23], a[8:11], v[152:155]
ds_read_b64_tr_b16 a[64:65], v249 offset:12288
v_mfma_f32_16x16x32_bf16 v[156:159], a[20:23], a[12:15], v[156:159]
ds_read_b64_tr_b16 a[66:67], v249 offset:12800
v_mfma_f32_16x16x32_bf16 v[160:163], a[0:3], a[24:27], v[160:163]
ds_read_b64_tr_b16 a[68:69], v248 offset:13312
v_mfma_f32_16x16x32_bf16 v[164:167], a[4:7], a[24:27], v[164:167]
ds_read_b64_tr_b16 a[70:71], v248 offset:13824
buffer_load_dwordx4 v105, s[20:23], s51 offen offset:1024 lds
s_lshl_b32 s63, s68, 3
s_mov_b32 exec_lo, 1
s_mov_b32 exec_hi, 1
buffer_store_dwordx2 v[92:93], v97, s[24:27], s63 offen sc1
s_mov_b64 exec, -1
v_mfma_f32_16x16x32_bf16 v[168:171], a[8:11], a[24:27], v[168:171]
ds_read_b64_tr_b16 a[72:73], v249 offset:13312
v_mfma_f32_16x16x32_bf16 v[172:175], a[12:15], a[24:27], v[172:175]
ds_read_b64_tr_b16 a[74:75], v249 offset:13824
v_mfma_f32_16x16x32_bf16 v[176:179], a[0:3], a[28:31], v[176:179]
ds_read_b64_tr_b16 a[76:77], v248 offset:14336
buffer_load_dwordx4 v106, s[20:23], s51 offen offset:2048 lds
v_mfma_f32_16x16x32_bf16 v[180:183], a[4:7], a[28:31], v[180:183]
ds_read_b64_tr_b16 a[78:79], v248 offset:14848
v_mfma_f32_16x16x32_bf16 v[184:187], a[8:11], a[28:31], v[184:187]
ds_read_b64_tr_b16 a[80:81], v249 offset:14336
v_mfma_f32_16x16x32_bf16 v[188:191], a[12:15], a[28:31], v[188:191]
ds_read_b64_tr_b16 a[82:83], v249 offset:14848
buffer_load_dwordx4 v107, s[20:23], s51 offen offset:3072 lds
v_mfma_f32_16x16x32_bf16 v[192:195], a[0:3], a[32:35], v[192:195]
v_mfma_f32_16x16x32_bf16 v[196:199], a[4:7], a[32:35], v[196:199]
s_add_u32 m0, s54, 53248
v_mfma_f32_16x16x32_bf16 v[200:203], a[8:11], a[32:35], v[200:203]
buffer_load_dwordx4 v108, s[20:23], s51 offen offset:0 lds
v_mfma_f32_16x16x32_bf16 v[204:207], a[12:15], a[32:35], v[204:207]
v_mfma_f32_16x16x32_bf16 v[208:211], a[0:3], a[36:39], v[208:211]
v_mfma_f32_16x16x32_bf16 v[212:215], a[4:7], a[36:39], v[212:215]
buffer_load_dwordx4 v109, s[20:23], s51 offen offset:1024 lds
v_mfma_f32_16x16x32_bf16 v[216:219], a[8:11], a[36:39], v[216:219]
v_mfma_f32_16x16x32_bf16 v[220:223], a[12:15], a[36:39], v[220:223]
s_waitcnt vmcnt(11) lgkmcnt(0)
s_barrier
v_mfma_f32_16x16x32_bf16 v[128:131], a[60:63], a[44:47], v[128:131]
ds_read_b64_tr_b16 a[16:17], v118 offset:0
v_cvt_pk_bf16_f32 v65, v64, v64
v_mfma_f32_16x16x32_bf16 v[132:135], a[60:63], a[48:51], v[132:135]
ds_read_b64_tr_b16 a[18:19], v118 offset:512
v_and_b32 v65, 0xffff0000, v65
v_mfma_f32_16x16x32_bf16 v[136:139], a[60:63], a[52:55], v[136:139]
ds_read_b128 a[0:3], v116 offset:0
s_lshl_b32 s50, s48, 7
v_sub_f32 v65, v64, v65
v_mfma_f32_16x16x32_bf16 v[140:143], a[60:63], a[56:59], v[140:143]
ds_read_b128 a[4:7], v116 offset:2048
s_add_u32 s50, s50, s58
v_cvt_pk_bf16_f32 v64, v64, v65
v_mfma_f32_16x16x32_bf16 v[144:147], a[64:67], a[44:47], v[144:147]
ds_read_b128 a[8:11], v116 offset:4096
s_mul_i32 s51, s48, 196608
v_mov_b32 v65, v93
v_mfma_f32_16x16x32_bf16 v[148:151], a[64:67], a[48:51], v[148:151]
ds_read_b128 a[12:15], v116 offset:6144
s_add_u32 s51, s51, s59
v_mov_b32 v66, 0
v_mfma_f32_16x16x32_bf16 v[152:155], a[64:67], a[52:55], v[152:155]
ds_read_b64_tr_b16 a[20:21], v119 offset:0
s_add_u32 s48, s48, 1
v_mov_b32 v67, v93
v_mfma_f32_16x16x32_bf16 v[156:159], a[64:67], a[56:59], v[156:159]
ds_read_b64_tr_b16 a[22:23], v119 offset:512
s_and_b32 s48, s48, 7
v_mfma_f32_16x16x32_bf16 v[160:163], a[44:47], a[68:71], v[160:163]
ds_read_b64_tr_b16 a[24:25], v118 offset:1024
s_add_u32 m0, s53, 98304
v_cvt_pk_bf16_f32 v69, v68, v68
v_mfma_f32_16x16x32_bf16 v[164:167], a[48:51], a[68:71], v[164:167]
ds_read_b64_tr_b16 a[26:27], v118 offset:1536
buffer_load_dwordx4 v100, s[16:19], s50 offen offset:0 lds
v_and_b32 v69, 0xffff0000, v69
v_mfma_f32_16x16x32_bf16 v[168:171], a[52:55], a[68:71], v[168:171]
ds_read_b64_tr_b16 a[28:29], v119 offset:1024
v_sub_f32 v69, v68, v69
v_mfma_f32_16x16x32_bf16 v[172:175], a[56:59], a[68:71], v[172:175]
ds_read_b64_tr_b16 a[30:31], v119 offset:1536
v_cvt_pk_bf16_f32 v68, v68, v69
v_mfma_f32_16x16x32_bf16 v[176:179], a[44:47], a[72:75], v[176:179]
ds_read_b64_tr_b16 a[32:33], v118 offset:2048
buffer_load_dwordx4 v101, s[16:19], s50 offen offset:1024 lds
v_mov_b32 v69, v93
v_mfma_f32_16x16x32_bf16 v[180:183], a[48:51], a[72:75], v[180:183]
ds_read_b64_tr_b16 a[34:35], v118 offset:2560
v_mov_b32 v70, 0
v_mfma_f32_16x16x32_bf16 v[184:187], a[52:55], a[72:75], v[184:187]
ds_read_b64_tr_b16 a[36:37], v119 offset:2048
v_mov_b32 v71, v93
v_mfma_f32_16x16x32_bf16 v[188:191], a[56:59], a[72:75], v[188:191]
ds_read_b64_tr_b16 a[38:39], v119 offset:2560
buffer_load_dwordx4 v102, s[16:19], s50 offen offset:2048 lds
v_mfma_f32_16x16x32_bf16 v[192:195], a[44:47], a[76:79], v[192:195]
v_cvt_pk_bf16_f32 v73, v72, v72
v_mfma_f32_16x16x32_bf16 v[196:199], a[48:51], a[76:79], v[196:199]
v_and_b32 v73, 0xffff0000, v73
v_mfma_f32_16x16x32_bf16 v[200:203], a[52:55], a[76:79], v[200:203]
buffer_load_dwordx4 v103, s[16:19], s50 offen offset:3072 lds
v_sub_f32 v73, v72, v73
v_mfma_f32_16x16x32_bf16 v[204:207], a[56:59], a[76:79], v[204:207]
v_cvt_pk_bf16_f32 v72, v72, v73
v_mfma_f32_16x16x32_bf16 v[208:211], a[44:47], a[80:83], v[208:211]
s_add_u32 m0, s54, 98304
v_mov_b32 v73, v93
v_mfma_f32_16x16x32_bf16 v[212:215], a[48:51], a[80:83], v[212:215]
buffer_load_dwordx4 v104, s[20:23], s51 offen offset:0 lds
v_mov_b32 v74, 0
v_mfma_f32_16x16x32_bf16 v[216:219], a[52:55], a[80:83], v[216:219]
v_mov_b32 v75, v93
v_mfma_f32_16x16x32_bf16 v[220:223], a[56:59], a[80:83], v[220:223]
s_waitcnt lgkmcnt(0)
v_mfma_f32_16x16x32_bf16 v[128:131], a[16:19], a[0:3], v[128:131]
ds_read_b64_tr_b16 a[60:61], v118 offset:12288
s_lshl_b32 s52, s49, 8
v_mfma_f32_16x16x32_bf16 v[132:135], a[16:19], a[4:7], v[132:135]
ds_read_b64_tr_b16 a[62:63], v118 offset:12800
s_add_u32 s52, s52, s57
v_mfma_f32_16x16x32_bf16 v[136:139], a[16:19], a[8:11], v[136:139]
ds_read_b128 a[44:47], v117 offset:0
s_mul_i32 s62, s41, 3072
v_mfma_f32_16x16x32_bf16 v[140:143], a[16:19], a[12:15], v[140:143]
ds_read_b128 a[48:51], v117 offset:2048
s_add_u32 s52, s52, s62
v_mfma_f32_16x16x32_bf16 v[144:147], a[20:23], a[0:3], v[144:147]
ds_read_b128 a[52:55], v117 offset:4096
v_mfma_f32_16x16x32_bf16 v[148:151], a[20:23], a[4:7], v[148:151]
ds_read_b128 a[56:59], v117 offset:6144
v_mfma_f32_16x16x32_bf16 v[152:155], a[20:23], a[8:11], v[152:155]
ds_read_b64_tr_b16 a[64:65], v119 offset:12288
v_mfma_f32_16x16x32_bf16 v[156:159], a[20:23], a[12:15], v[156:159]
ds_read_b64_tr_b16 a[66:67], v119 offset:12800
v_mfma_f32_16x16x32_bf16 v[160:163], a[0:3], a[24:27], v[160:163]
ds_read_b64_tr_b16 a[68:69], v118 offset:13312
s_cmp_lt_u32 s43, 4
s_cbranch_scc0 L_cstq
s_mov_b64 exec, 0xffff
buffer_store_dwordx4 v[64:67], v96, s[24:27], s52 offen offset:0 sc1
buffer_store_dwordx4 v[68:71], v96, s[24:27], s52 offen offset:1024 sc1
buffer_store_dwordx4 v[72:75], v96, s[24:27], s52 offen offset:2048 sc1
s_mov_b64 exec, -1
L_cstq:
v_mfma_f32_16x16x32_bf16 v[164:167], a[4:7], a[24:27], v[164:167]
ds_read_b64_tr_b16 a[70:71], v118 offset:13824
buffer_load_dwordx4 v105, s[20:23], s51 offen offset:1024 lds
v_mfma_f32_16x16x32_bf16 v[168:171], a[8:11], a[24:27], v[168:171]
ds_read_b64_tr_b16 a[72:73], v119 offset:13312
v_mfma_f32_16x16x32_bf16 v[172:175], a[12:15], a[24:27], v[172:175]
ds_read_b64_tr_b16 a[74:75], v119 offset:13824
v_mfma_f32_16x16x32_bf16 v[176:179], a[0:3], a[28:31], v[176:179]
ds_read_b64_tr_b16 a[76:77], v118 offset:14336
buffer_load_dwordx4 v106, s[20:23], s51 offen offset:2048 lds
v_mfma_f32_16x16x32_bf16 v[180:183], a[4:7], a[28:31], v[180:183]
ds_read_b64_tr_b16 a[78:79], v118 offset:14848
v_mfma_f32_16x16x32_bf16 v[184:187], a[8:11], a[28:31], v[184:187]
ds_read_b64_tr_b16 a[80:81], v119 offset:14336
v_mfma_f32_16x16x32_bf16 v[188:191], a[12:15], a[28:31], v[188:191]
ds_read_b64_tr_b16 a[82:83], v119 offset:14848
buffer_load_dwordx4 v107, s[20:23], s51 offen offset:3072 lds
v_mfma_f32_16x16x32_bf16 v[192:195], a[0:3], a[32:35], v[192:195]
v_mfma_f32_16x16x32_bf16 v[196:199], a[4:7], a[32:35], v[196:199]
s_add_u32 m0, s54, 102400
v_mfma_f32_16x16x32_bf16 v[200:203], a[8:11], a[32:35], v[200:203]
buffer_load_dwordx4 v108, s[20:23], s51 offen offset:0 lds
v_mfma_f32_16x16x32_bf16 v[204:207], a[12:15], a[32:35], v[204:207]
v_mfma_f32_16x16x32_bf16 v[208:211], a[0:3], a[36:39], v[208:211]
v_mfma_f32_16x16x32_bf16 v[212:215], a[4:7], a[36:39], v[212:215]
buffer_load_dwordx4 v109, s[20:23], s51 offen offset:1024 lds
v_mfma_f32_16x16x32_bf16 v[216:219], a[8:11], a[36:39], v[216:219]
v_mfma_f32_16x16x32_bf16 v[220:223], a[12:15], a[36:39], v[220:223]
s_waitcnt vmcnt(10) lgkmcnt(0)
s_barrier
v_mfma_f32_16x16x32_bf16 v[128:131], a[60:63], a[44:47], v[128:131]
ds_read_b64_tr_b16 a[16:17], v127 offset:0
v_mfma_f32_16x16x32_bf16 v[132:135], a[60:63], a[48:51], v[132:135]
ds_read_b64_tr_b16 a[18:19], v127 offset:512
v_mfma_f32_16x16x32_bf16 v[136:139], a[60:63], a[52:55], v[136:139]
ds_read_b128 a[0:3], v125 offset:0
s_lshl_b32 s50, s48, 7
v_mfma_f32_16x16x32_bf16 v[140:143], a[60:63], a[56:59], v[140:143]
ds_read_b128 a[4:7], v125 offset:2048
s_add_u32 s50, s50, s58
v_mfma_f32_16x16x32_bf16 v[144:147], a[64:67], a[44:47], v[144:147]
ds_read_b128 a[8:11], v125 offset:4096
s_mul_i32 s51, s48, 196608
v_mfma_f32_16x16x32_bf16 v[148:151], a[64:67], a[48:51], v[148:151]
ds_read_b128 a[12:15], v125 offset:6144
s_add_u32 s51, s51, s59
v_mfma_f32_16x16x32_bf16 v[152:155], a[64:67], a[52:55], v[152:155]
ds_read_b64_tr_b16 a[20:21], v240 offset:0
s_add_u32 s48, s48, 1
v_mfma_f32_16x16x32_bf16 v[156:159], a[64:67], a[56:59], v[156:159]
ds_read_b64_tr_b16 a[22:23], v240 offset:512
s_and_b32 s48, s48, 7
v_mfma_f32_16x16x32_bf16 v[160:163], a[44:47], a[68:71], v[160:163]
ds_read_b64_tr_b16 a[24:25], v127 offset:1024
s_add_u32 m0, s53, 0
v_mfma_f32_16x16x32_bf16 v[164:167], a[48:51], a[68:71], v[164:167]
ds_read_b64_tr_b16 a[26:27], v127 offset:1536
buffer_load_dwordx4 v100, s[16:19], s50 offen offset:0 lds
v_mfma_f32_16x16x32_bf16 v[168:171], a[52:55], a[68:71], v[168:171]
ds_read_b64_tr_b16 a[28:29], v240 offset:1024
v_mfma_f32_16x16x32_bf16 v[172:175], a[56:59], a[68:71], v[172:175]
ds_read_b64_tr_b16 a[30:31], v240 offset:1536
v_mfma_f32_16x16x32_bf16 v[176:179], a[44:47], a[72:75], v[176:179]
ds_read_b64_tr_b16 a[32:33], v127 offset:2048
buffer_load_dwordx4 v101, s[16:19], s50 offen offset:1024 lds
v_mfma_f32_16x16x32_bf16 v[180:183], a[48:51], a[72:75], v[180:183]
ds_read_b64_tr_b16 a[34:35], v127 offset:2560
v_mfma_f32_16x16x32_bf16 v[184:187], a[52:55], a[72:75], v[184:187]
ds_read_b64_tr_b16 a[36:37], v240 offset:2048
v_mfma_f32_16x16x32_bf16 v[188:191], a[56:59], a[72:75], v[188:191]
ds_read_b64_tr_b16 a[38:39], v240 offset:2560
buffer_load_dwordx4 v102, s[16:19], s50 offen offset:2048 lds
v_mfma_f32_16x16x32_bf16 v[192:195], a[44:47], a[76:79], v[192:195]
v_mfma_f32_16x16x32_bf16 v[196:199], a[48:51], a[76:79], v[196:199]
v_mfma_f32_16x16x32_bf16 v[200:203], a[52:55], a[76:79], v[200:203]
buffer_load_dwordx4 v103, s[16:19], s50 offen offset:3072 lds
v_mfma_f32_16x16x32_bf16 v[204:207], a[56:59], a[76:79], v[204:207]
v_mfma_f32_16x16x32_bf16 v[208:211], a[44:47], a[80:83], v[208:211]
s_add_u32 m0, s54, 0
v_mfma_f32_16x16x32_bf16 v[212:215], a[48:51], a[80:83], v[212:215]
buffer_load_dwordx4 v104, s[20:23], s51 offen offset:0 lds
v_mfma_f32_16x16x32_bf16 v[216:219], a[52:55], a[80:83], v[216:219]
v_mfma_f32_16x16x32_bf16 v[220:223], a[56:59], a[80:83], v[220:223]
s_waitcnt lgkmcnt(0)
v_mfma_f32_16x16x32_bf16 v[128:131], a[16:19], a[0:3], v[128:131]
ds_read_b64_tr_b16 a[60:61], v127 offset:12288
v_mfma_f32_16x16x32_bf16 v[132:135], a[16:19], a[4:7], v[132:135]
ds_read_b64_tr_b16 a[62:63], v127 offset:12800
v_mfma_f32_16x16x32_bf16 v[136:139], a[16:19], a[8:11], v[136:139]
ds_read_b128 a[44:47], v126 offset:0
v_mfma_f32_16x16x32_bf16 v[140:143], a[16:19], a[12:15], v[140:143]
ds_read_b128 a[48:51], v126 offset:2048
v_mfma_f32_16x16x32_bf16 v[144:147], a[20:23], a[0:3], v[144:147]
ds_read_b128 a[52:55], v126 offset:4096
v_mfma_f32_16x16x32_bf16 v[148:151], a[20:23], a[4:7], v[148:151]
ds_read_b128 a[56:59], v126 offset:6144
v_mfma_f32_16x16x32_bf16 v[152:155], a[20:23], a[8:11], v[152:155]
ds_read_b64_tr_b16 a[64:65], v240 offset:12288
v_mfma_f32_16x16x32_bf16 v[156:159], a[20:23], a[12:15], v[156:159]
ds_read_b64_tr_b16 a[66:67], v240 offset:12800
v_mfma_f32_16x16x32_bf16 v[160:163], a[0:3], a[24:27], v[160:163]
ds_read_b64_tr_b16 a[68:69], v127 offset:13312
v_mfma_f32_16x16x32_bf16 v[164:167], a[4:7], a[24:27], v[164:167]
ds_read_b64_tr_b16 a[70:71], v127 offset:13824
buffer_load_dwordx4 v105, s[20:23], s51 offen offset:1024 lds
v_mfma_f32_16x16x32_bf16 v[168:171], a[8:11], a[24:27], v[168:171]
ds_read_b64_tr_b16 a[72:73], v240 offset:13312
v_mfma_f32_16x16x32_bf16 v[172:175], a[12:15], a[24:27], v[172:175]
ds_read_b64_tr_b16 a[74:75], v240 offset:13824
v_mfma_f32_16x16x32_bf16 v[176:179], a[0:3], a[28:31], v[176:179]
ds_read_b64_tr_b16 a[76:77], v127 offset:14336
buffer_load_dwordx4 v106, s[20:23], s51 offen offset:2048 lds
v_mfma_f32_16x16x32_bf16 v[180:183], a[4:7], a[28:31], v[180:183]
ds_read_b64_tr_b16 a[78:79], v127 offset:14848
v_mfma_f32_16x16x32_bf16 v[184:187], a[8:11], a[28:31], v[184:187]
ds_read_b64_tr_b16 a[80:81], v240 offset:14336
v_mfma_f32_16x16x32_bf16 v[188:191], a[12:15], a[28:31], v[188:191]
ds_read_b64_tr_b16 a[82:83], v240 offset:14848
buffer_load_dwordx4 v107, s[20:23], s51 offen offset:3072 lds
v_mfma_f32_16x16x32_bf16 v[192:195], a[0:3], a[32:35], v[192:195]
v_mfma_f32_16x16x32_bf16 v[196:199], a[4:7], a[32:35], v[196:199]
s_add_u32 m0, s54, 4096
v_mfma_f32_16x16x32_bf16 v[200:203], a[8:11], a[32:35], v[200:203]
buffer_load_dwordx4 v108, s[20:23], s51 offen offset:0 lds
v_mfma_f32_16x16x32_bf16 v[204:207], a[12:15], a[32:35], v[204:207]
v_mfma_f32_16x16x32_bf16 v[208:211], a[0:3], a[36:39], v[208:211]
v_mfma_f32_16x16x32_bf16 v[212:215], a[4:7], a[36:39], v[212:215]
buffer_load_dwordx4 v109, s[20:23], s51 offen offset:1024 lds
v_mfma_f32_16x16x32_bf16 v[216:219], a[8:11], a[36:39], v[216:219]
v_mfma_f32_16x16x32_bf16 v[220:223], a[12:15], a[36:39], v[220:223]
s_waitcnt vmcnt(10) lgkmcnt(0)
s_barrier
v_mfma_f32_16x16x32_bf16 v[128:131], a[60:63], a[44:47], v[128:131]
ds_read_b64_tr_b16 a[16:17], v248 offset:0
s_mul_i32 s62, s42, 6144
v_mfma_f32_16x16x32_bf16 v[132:135], a[60:63], a[48:51], v[132:135]
ds_read_b64_tr_b16 a[18:19], v248 offset:512
s_sub_u32 s62, s57, s62
v_mfma_f32_16x16x32_bf16 v[136:139], a[60:63], a[52:55], v[136:139]
ds_read_b128 a[0:3], v246 offset:0
s_lshl_b32 s50, s48, 7
s_lshl_b32 s64, s40, 12
v_mfma_f32_16x16x32_bf16 v[140:143], a[60:63], a[56:59], v[140:143]
ds_read_b128 a[4:7], v246 offset:2048
s_add_u32 s50, s50, s58
s_add_u32 s62, s62, s64
v_mfma_f32_16x16x32_bf16 v[144:147], a[64:67], a[44:47], v[144:147]
ds_read_b128 a[8:11], v246 offset:4096
s_mul_i32 s51, s48, 196608
s_add_u32 s64, s64, 147456
v_mfma_f32_16x16x32_bf16 v[148:151], a[64:67], a[48:51], v[148:151]
ds_read_b128 a[12:15], v246 offset:6144
s_add_u32 s51, s51, s59
s_lshl_b32 s63, s43, 10
v_mfma_f32_16x16x32_bf16 v[152:155], a[64:67], a[52:55], v[152:155]
ds_read_b64_tr_b16 a[20:21], v249 offset:0
s_add_u32 s48, s48, 1
s_add_u32 s65, s62, 3072
v_mfma_f32_16x16x32_bf16 v[156:159], a[64:67], a[56:59], v[156:159]
ds_read_b64_tr_b16 a[22:23], v249 offset:512
s_and_b32 s48, s48, 7
s_cmp_eq_u32 s40, 3
s_cselect_b32 s63, s63, s65
v_mfma_f32_16x16x32_bf16 v[160:163], a[44:47], a[68:71], v[160:163]
ds_read_b64_tr_b16 a[24:25], v248 offset:1024
s_add_u32 m0, s53, 49152
v_mfma_f32_16x16x32_bf16 v[164:167], a[48:51], a[68:71], v[164:167]
ds_read_b64_tr_b16 a[26:27], v248 offset:1536
buffer_load_dwordx4 v100, s[16:19], s50 offen offset:0 lds
v_mfma_f32_16x16x32_bf16 v[168:171], a[52:55], a[68:71], v[168:171]
ds_read_b64_tr_b16 a[28:29], v249 offset:1024
v_mfma_f32_16x16x32_bf16 v[172:175], a[56:59], a[68:71], v[172:175]
ds_read_b64_tr_b16 a[30:31], v249 offset:1536
v_mfma_f32_16x16x32_bf16 v[176:179], a[44:47], a[72:75], v[176:179]
ds_read_b64_tr_b16 a[32:33], v248 offset:2048
buffer_load_dwordx4 v101, s[16:19], s50 offen offset:1024 lds
v_mfma_f32_16x16x32_bf16 v[180:183], a[48:51], a[72:75], v[180:183]
ds_read_b64_tr_b16 a[34:35], v248 offset:2560
v_mfma_f32_16x16x32_bf16 v[184:187], a[52:55], a[72:75], v[184:187]
ds_read_b64_tr_b16 a[36:37], v249 offset:2048
v_mfma_f32_16x16x32_bf16 v[188:191], a[56:59], a[72:75], v[188:191]
ds_read_b64_tr_b16 a[38:39], v249 offset:2560
buffer_load_dwordx4 v102, s[16:19], s50 offen offset:2048 lds
v_mfma_f32_16x16x32_bf16 v[192:195], a[44:47], a[76:79], v[192:195]
v_mfma_f32_16x16x32_bf16 v[196:199], a[48:51], a[76:79], v[196:199]
v_mfma_f32_16x16x32_bf16 v[200:203], a[52:55], a[76:79], v[200:203]
buffer_load_dwordx4 v103, s[16:19], s50 offen offset:3072 lds
v_mfma_f32_16x16x32_bf16 v[204:207], a[56:59], a[76:79], v[204:207]
v_mfma_f32_16x16x32_bf16 v[208:211], a[44:47], a[80:83], v[208:211]
s_add_u32 m0, s54, 49152
v_mfma_f32_16x16x32_bf16 v[212:215], a[48:51], a[80:83], v[212:215]
buffer_load_dwordx4 v104, s[20:23], s51 offen offset:0 lds
v_mfma_f32_16x16x32_bf16 v[216:219], a[52:55], a[80:83], v[216:219]
v_mfma_f32_16x16x32_bf16 v[220:223], a[56:59], a[80:83], v[220:223]
s_waitcnt lgkmcnt(0)
v_mfma_f32_16x16x32_bf16 v[128:131], a[16:19], a[0:3], v[128:131]
ds_read_b64_tr_b16 a[60:61], v248 offset:12288
s_mov_b32 s65, m0
s_mov_b32 m0, s64
v_mfma_f32_16x16x32_bf16 v[132:135], a[16:19], a[4:7], v[132:135]
ds_read_b64_tr_b16 a[62:63], v248 offset:12800
buffer_load_dwordx4 v95, s[24:27], s62 offen offset:0 sc1 lds
v_mfma_f32_16x16x32_bf16 v[136:139], a[16:19], a[8:11], v[136:139]
ds_read_b128 a[44:47], v247 offset:0
v_mfma_f32_16x16x32_bf16 v[140:143], a[16:19], a[12:15], v[140:143]
ds_read_b128 a[48:51], v247 offset:2048
buffer_load_dwordx4 v95, s[24:27], s62 offen offset:1024 sc1 lds
v_mfma_f32_16x16x32_bf16 v[144:147], a[20:23], a[0:3], v[144:147]
ds_read_b128 a[52:55], v247 offset:4096
v_mfma_f32_16x16x32_bf16 v[148:151], a[20:23], a[4:7], v[148:151]
ds_read_b128 a[56:59], v247 offset:6144
buffer_load_dwordx4 v95, s[24:27], s62 offen offset:2048 sc1 lds
v_mfma_f32_16x16x32_bf16 v[152:155], a[20:23], a[8:11], v[152:155]
ds_read_b64_tr_b16 a[64:65], v249 offset:12288
s_add_u32 m0, s64, 3072
v_mfma_f32_16x16x32_bf16 v[156:159], a[20:23], a[12:15], v[156:159]
ds_read_b64_tr_b16 a[66:67], v249 offset:12800
buffer_load_dwordx4 v95, s[24:27], s63 offen offset:0 sc1 lds
v_mfma_f32_16x16x32_bf16 v[160:163], a[0:3], a[24:27], v[160:163]
ds_read_b64_tr_b16 a[68:69], v248 offset:13312
s_mov_b32 m0, s65
v_mfma_f32_16x16x32_bf16 v[164:167], a[4:7], a[24:27], v[164:167]
ds_read_b64_tr_b16 a[70:71], v248 offset:13824
buffer_load_dwordx4 v105, s[20:23], s51 offen offset:1024 lds
v_mfma_f32_16x16x32_bf16 v[168:171], a[8:11], a[24:27], v[168:171]
ds_read_b64_tr_b16 a[72:73], v249 offset:13312
v_mfma_f32_16x16x32_bf16 v[172:175], a[12:15], a[24:27], v[172:175]
ds_read_b64_tr_b16 a[74:75], v249 offset:13824
v_mfma_f32_16x16x32_bf16 v[176:179], a[0:3], a[28:31], v[176:179]
ds_read_b64_tr_b16 a[76:77], v248 offset:14336
buffer_load_dwordx4 v106, s[20:23], s51 offen offset:2048 lds
v_mfma_f32_16x16x32_bf16 v[180:183], a[4:7], a[28:31], v[180:183]
ds_read_b64_tr_b16 a[78:79], v248 offset:14848
v_mfma_f32_16x16x32_bf16 v[184:187], a[8:11], a[28:31], v[184:187]
ds_read_b64_tr_b16 a[80:81], v249 offset:14336
v_mfma_f32_16x16x32_bf16 v[188:191], a[12:15], a[28:31], v[188:191]
ds_read_b64_tr_b16 a[82:83], v249 offset:14848
buffer_load_dwordx4 v107, s[20:23], s51 offen offset:3072 lds
v_mfma_f32_16x16x32_bf16 v[192:195], a[0:3], a[32:35], v[192:195]
v_mfma_f32_16x16x32_bf16 v[196:199], a[4:7], a[32:35], v[196:199]
s_add_u32 m0, s54, 53248
v_mfma_f32_16x16x32_bf16 v[200:203], a[8:11], a[32:35], v[200:203]
buffer_load_dwordx4 v108, s[20:23], s51 offen offset:0 lds
v_mfma_f32_16x16x32_bf16 v[204:207], a[12:15], a[32:35], v[204:207]
v_mfma_f32_16x16x32_bf16 v[208:211], a[0:3], a[36:39], v[208:211]
v_mfma_f32_16x16x32_bf16 v[212:215], a[4:7], a[36:39], v[212:215]
buffer_load_dwordx4 v109, s[20:23], s51 offen offset:1024 lds
v_mfma_f32_16x16x32_bf16 v[216:219], a[8:11], a[36:39], v[216:219]
v_mfma_f32_16x16x32_bf16 v[220:223], a[12:15], a[36:39], v[220:223]
s_waitcnt vmcnt(14) lgkmcnt(0)
s_barrier
v_mfma_f32_16x16x32_bf16 v[128:131], a[60:63], a[44:47], v[128:131]
ds_read_b64_tr_b16 a[16:17], v118 offset:0
s_mul_i32 s62, s42, 6144
v_mfma_f32_16x16x32_bf16 v[132:135], a[60:63], a[48:51], v[132:135]
ds_read_b64_tr_b16 a[18:19], v118 offset:512
s_add_u32 s62, s62, 147456
v_mfma_f32_16x16x32_bf16 v[136:139], a[60:63], a[52:55], v[136:139]
ds_read_b128 a[0:3], v116 offset:0
v_add_u32 v16, s62, v95
v_mfma_f32_16x16x32_bf16 v[140:143], a[60:63], a[56:59], v[140:143]
ds_read_b128 a[4:7], v116 offset:2048
s_lshl_b32 s62, s41, 9
v_mfma_f32_16x16x32_bf16 v[144:147], a[64:67], a[44:47], v[144:147]
ds_read_b128 a[8:11], v116 offset:4096
s_add_u32 s62, s62, 162816
v_mfma_f32_16x16x32_bf16 v[148:151], a[64:67], a[48:51], v[148:151]
ds_read_b128 a[12:15], v116 offset:6144
v_add_u32 v17, s62, v94
v_mfma_f32_16x16x32_bf16 v[152:155], a[64:67], a[52:55], v[152:155]
ds_read_b64_tr_b16 a[20:21], v119 offset:0
s_add_u32 m0, s55, 98304
v_mfma_f32_16x16x32_bf16 v[156:159], a[64:67], a[56:59], v[156:159]
ds_read_b64_tr_b16 a[22:23], v119 offset:512
s_add_u32 s50, s12, 0
v_mfma_f32_16x16x32_bf16 v[160:163], a[44:47], a[68:71], v[160:163]
ds_read_b64_tr_b16 a[24:25], v118 offset:1024
s_add_u32 s51, s12, 0
v_mfma_f32_16x16x32_bf16 v[164:167], a[48:51], a[68:71], v[164:167]
ds_read_b64_tr_b16 a[26:27], v118 offset:1536
buffer_load_dwordx4 v112, s[72:75], s50 offen offset:0 lds
v_mfma_f32_16x16x32_bf16 v[168:171], a[52:55], a[68:71], v[168:171]
ds_read_b64_tr_b16 a[28:29], v119 offset:1024
v_mfma_f32_16x16x32_bf16 v[172:175], a[56:59], a[68:71], v[172:175]
ds_read_b64_tr_b16 a[30:31], v119 offset:1536
buffer_load_dwordx4 v113, s[72:75], s50 offen offset:1024 lds
v_mfma_f32_16x16x32_bf16 v[176:179], a[44:47], a[72:75], v[176:179]
ds_read_b64_tr_b16 a[32:33], v118 offset:2048
v_mfma_f32_16x16x32_bf16 v[180:183], a[48:51], a[72:75], v[180:183]
ds_read_b64_tr_b16 a[34:35], v118 offset:2560
buffer_load_dwordx4 v114, s[72:75], s51 offen offset:2048 lds
v_mfma_f32_16x16x32_bf16 v[184:187], a[52:55], a[72:75], v[184:187]
ds_read_b64_tr_b16 a[36:37], v119 offset:2048
v_mfma_f32_16x16x32_bf16 v[188:191], a[56:59], a[72:75], v[188:191]
ds_read_b64_tr_b16 a[38:39], v119 offset:2560
buffer_load_dwordx4 v115, s[72:75], s51 offen offset:3072 lds
s_add_u32 m0, s55, 102400
s_add_u32 s50, s12, 32768
v_mfma_f32_16x16x32_bf16 v[192:195], a[44:47], a[76:79], v[192:195]
s_add_u32 s51, s12, 32768
v_mfma_f32_16x16x32_bf16 v[196:199], a[48:51], a[76:79], v[196:199]
buffer_load_dwordx4 v112, s[72:75], s50 offen offset:0 lds
v_mfma_f32_16x16x32_bf16 v[200:203], a[52:55], a[76:79], v[200:203]
v_mfma_f32_16x16x32_bf16 v[204:207], a[56:59], a[76:79], v[204:207]
buffer_load_dwordx4 v113, s[72:75], s50 offen offset:1024 lds
v_mfma_f32_16x16x32_bf16 v[208:211], a[44:47], a[80:83], v[208:211]
v_mfma_f32_16x16x32_bf16 v[212:215], a[48:51], a[80:83], v[212:215]
v_mfma_f32_16x16x32_bf16 v[216:219], a[52:55], a[80:83], v[216:219]
v_mfma_f32_16x16x32_bf16 v[220:223], a[56:59], a[80:83], v[220:223]
s_waitcnt lgkmcnt(0)
v_mfma_f32_16x16x32_bf16 v[128:131], a[16:19], a[0:3], v[128:131]
ds_read_b64_tr_b16 a[60:61], v118 offset:12288
v_mfma_f32_16x16x32_bf16 v[132:135], a[16:19], a[4:7], v[132:135]
ds_read_b64_tr_b16 a[62:63], v118 offset:12800
v_mfma_f32_16x16x32_bf16 v[136:139], a[16:19], a[8:11], v[136:139]
ds_read_b128 a[44:47], v117 offset:0
v_mfma_f32_16x16x32_bf16 v[140:143], a[16:19], a[12:15], v[140:143]
ds_read_b128 a[48:51], v117 offset:2048
v_mfma_f32_16x16x32_bf16 v[144:147], a[20:23], a[0:3], v[144:147]
ds_read_b128 a[52:55], v117 offset:4096
v_mfma_f32_16x16x32_bf16 v[148:151], a[20:23], a[4:7], v[148:151]
ds_read_b128 a[56:59], v117 offset:6144
v_mfma_f32_16x16x32_bf16 v[152:155], a[20:23], a[8:11], v[152:155]
ds_read_b64_tr_b16 a[64:65], v119 offset:12288
v_mfma_f32_16x16x32_bf16 v[156:159], a[20:23], a[12:15], v[156:159]
ds_read_b64_tr_b16 a[66:67], v119 offset:12800
v_mfma_f32_16x16x32_bf16 v[160:163], a[0:3], a[24:27], v[160:163]
ds_read_b64_tr_b16 a[68:69], v118 offset:13312
v_mfma_f32_16x16x32_bf16 v[164:167], a[4:7], a[24:27], v[164:167]
ds_read_b64_tr_b16 a[70:71], v118 offset:13824
buffer_load_dwordx4 v114, s[72:75], s51 offen offset:2048 lds
v_mfma_f32_16x16x32_bf16 v[168:171], a[8:11], a[24:27], v[168:171]
ds_read_b64_tr_b16 a[72:73], v119 offset:13312
v_mfma_f32_16x16x32_bf16 v[172:175], a[12:15], a[24:27], v[172:175]
ds_read_b64_tr_b16 a[74:75], v119 offset:13824
buffer_load_dwordx4 v115, s[72:75], s51 offen offset:3072 lds
s_add_u32 m0, s55, 106496
s_add_u32 s50, s12, 65536
v_mfma_f32_16x16x32_bf16 v[176:179], a[0:3], a[28:31], v[176:179]
ds_read_b64_tr_b16 a[76:77], v118 offset:14336
s_add_u32 s51, s12, 65536
v_mfma_f32_16x16x32_bf16 v[180:183], a[4:7], a[28:31], v[180:183]
ds_read_b64_tr_b16 a[78:79], v118 offset:14848
buffer_load_dwordx4 v112, s[72:75], s50 offen offset:0 lds
v_mfma_f32_16x16x32_bf16 v[184:187], a[8:11], a[28:31], v[184:187]
ds_read_b64_tr_b16 a[80:81], v119 offset:14336
v_mfma_f32_16x16x32_bf16 v[188:191], a[12:15], a[28:31], v[188:191]
ds_read_b64_tr_b16 a[82:83], v119 offset:14848
buffer_load_dwordx4 v113, s[72:75], s50 offen offset:1024 lds
v_mfma_f32_16x16x32_bf16 v[192:195], a[0:3], a[32:35], v[192:195]
v_mfma_f32_16x16x32_bf16 v[196:199], a[4:7], a[32:35], v[196:199]
buffer_load_dwordx4 v114, s[72:75], s51 offen offset:2048 lds
v_mfma_f32_16x16x32_bf16 v[200:203], a[8:11], a[32:35], v[200:203]
v_mfma_f32_16x16x32_bf16 v[204:207], a[12:15], a[32:35], v[204:207]
buffer_load_dwordx4 v115, s[72:75], s51 offen offset:3072 lds
v_mfma_f32_16x16x32_bf16 v[208:211], a[0:3], a[36:39], v[208:211]
v_mfma_f32_16x16x32_bf16 v[212:215], a[4:7], a[36:39], v[212:215]
v_mfma_f32_16x16x32_bf16 v[216:219], a[8:11], a[36:39], v[216:219]
v_mfma_f32_16x16x32_bf16 v[220:223], a[12:15], a[36:39], v[220:223]
s_waitcnt vmcnt(12) lgkmcnt(0)
s_barrier
v_mfma_f32_16x16x32_bf16 v[128:131], a[60:63], a[44:47], v[128:131]
ds_read_b64_tr_b16 a[16:17], v127 offset:0
v_mfma_f32_16x16x32_bf16 v[132:135], a[60:63], a[48:51], v[132:135]
ds_read_b64_tr_b16 a[18:19], v127 offset:512
v_mfma_f32_16x16x32_bf16 v[136:139], a[60:63], a[52:55], v[136:139]
ds_read_b128 a[0:3], v125 offset:0
v_mfma_f32_16x16x32_bf16 v[140:143], a[60:63], a[56:59], v[140:143]
ds_read_b128 a[4:7], v125 offset:2048
v_mfma_f32_16x16x32_bf16 v[144:147], a[64:67], a[44:47], v[144:147]
ds_read_b128 a[8:11], v125 offset:4096
v_mfma_f32_16x16x32_bf16 v[148:151], a[64:67], a[48:51], v[148:151]
ds_read_b128 a[12:15], v125 offset:6144
v_mfma_f32_16x16x32_bf16 v[152:155], a[64:67], a[52:55], v[152:155]
ds_read_b64_tr_b16 a[20:21], v240 offset:0
s_add_u32 m0, s55, 0
v_mfma_f32_16x16x32_bf16 v[156:159], a[64:67], a[56:59], v[156:159]
ds_read_b64_tr_b16 a[22:23], v240 offset:512
s_add_u32 s50, s13, 0
v_mfma_f32_16x16x32_bf16 v[160:163], a[44:47], a[68:71], v[160:163]
ds_read_b64_tr_b16 a[24:25], v127 offset:1024
s_add_u32 s51, s13, 0
v_mfma_f32_16x16x32_bf16 v[164:167], a[48:51], a[68:71], v[164:167]
ds_read_b64_tr_b16 a[26:27], v127 offset:1536
buffer_load_dwordx4 v112, s[72:75], s50 offen offset:0 lds
v_mfma_f32_16x16x32_bf16 v[168:171], a[52:55], a[68:71], v[168:171]
ds_read_b64_tr_b16 a[28:29], v240 offset:1024
v_mfma_f32_16x16x32_bf16 v[172:175], a[56:59], a[68:71], v[172:175]
ds_read_b64_tr_b16 a[30:31], v240 offset:1536
buffer_load_dwordx4 v113, s[72:75], s50 offen offset:1024 lds
v_mfma_f32_16x16x32_bf16 v[176:179], a[44:47], a[72:75], v[176:179]
ds_read_b64_tr_b16 a[32:33], v127 offset:2048
v_mfma_f32_16x16x32_bf16 v[180:183], a[48:51], a[72:75], v[180:183]
ds_read_b64_tr_b16 a[34:35], v127 offset:2560
buffer_load_dwordx4 v114, s[72:75], s51 offen offset:2048 lds
v_mfma_f32_16x16x32_bf16 v[184:187], a[52:55], a[72:75], v[184:187]
ds_read_b64_tr_b16 a[36:37], v240 offset:2048
v_mfma_f32_16x16x32_bf16 v[188:191], a[56:59], a[72:75], v[188:191]
ds_read_b64_tr_b16 a[38:39], v240 offset:2560
buffer_load_dwordx4 v115, s[72:75], s51 offen offset:3072 lds
s_add_u32 m0, s55, 4096
s_add_u32 s50, s13, 32768
v_mfma_f32_16x16x32_bf16 v[192:195], a[44:47], a[76:79], v[192:195]
s_add_u32 s51, s13, 32768
ds_read_b64 v[56:57], v17 offset:0
v_mfma_f32_16x16x32_bf16 v[196:199], a[48:51], a[76:79], v[196:199]
buffer_load_dwordx4 v112, s[72:75], s50 offen offset:0 lds
ds_read_b64 v[58:59], v17 offset:128
v_mfma_f32_16x16x32_bf16 v[200:203], a[52:55], a[76:79], v[200:203]
ds_read_b64 v[60:61], v17 offset:256
v_mfma_f32_16x16x32_bf16 v[204:207], a[56:59], a[76:79], v[204:207]
buffer_load_dwordx4 v113, s[72:75], s50 offen offset:1024 lds
ds_read_b64 v[62:63], v17 offset:384
v_mfma_f32_16x16x32_bf16 v[208:211], a[44:47], a[80:83], v[208:211]
ds_read_b128 v[64:67], v16 offset:0
v_mfma_f32_16x16x32_bf16 v[212:215], a[48:51], a[80:83], v[212:215]
v_mfma_f32_16x16x32_bf16 v[216:219], a[52:55], a[80:83], v[216:219]
v_mfma_f32_16x16x32_bf16 v[220:223], a[56:59], a[80:83], v[220:223]
s_waitcnt lgkmcnt(0)
v_mfma_f32_16x16x32_bf16 v[128:131], a[16:19], a[0:3], v[128:131]
ds_read_b64_tr_b16 a[60:61], v127 offset:12288
v_mfma_f32_16x16x32_bf16 v[132:135], a[16:19], a[4:7], v[132:135]
ds_read_b64_tr_b16 a[62:63], v127 offset:12800
v_mfma_f32_16x16x32_bf16 v[136:139], a[16:19], a[8:11], v[136:139]
ds_read_b128 a[44:47], v126 offset:0
v_mfma_f32_16x16x32_bf16 v[140:143], a[16:19], a[12:15], v[140:143]
ds_read_b128 a[48:51], v126 offset:2048
v_mfma_f32_16x16x32_bf16 v[144:147], a[20:23], a[0:3], v[144:147]
ds_read_b128 a[52:55], v126 offset:4096
v_mfma_f32_16x16x32_bf16 v[148:151], a[20:23], a[4:7], v[148:151]
ds_read_b128 a[56:59], v126 offset:6144
v_mfma_f32_16x16x32_bf16 v[152:155], a[20:23], a[8:11], v[152:155]
ds_read_b64_tr_b16 a[64:65], v240 offset:12288
v_mfma_f32_16x16x32_bf16 v[156:159], a[20:23], a[12:15], v[156:159]
ds_read_b64_tr_b16 a[66:67], v240 offset:12800
v_mfma_f32_16x16x32_bf16 v[160:163], a[0:3], a[24:27], v[160:163]
ds_read_b64_tr_b16 a[68:69], v127 offset:13312
v_mfma_f32_16x16x32_bf16 v[164:167], a[4:7], a[24:27], v[164:167]
ds_read_b64_tr_b16 a[70:71], v127 offset:13824
buffer_load_dwordx4 v114, s[72:75], s51 offen offset:2048 lds
v_mfma_f32_16x16x32_bf16 v[168:171], a[8:11], a[24:27], v[168:171]
ds_read_b64_tr_b16 a[72:73], v240 offset:13312
v_mfma_f32_16x16x32_bf16 v[172:175], a[12:15], a[24:27], v[172:175]
ds_read_b64_tr_b16 a[74:75], v240 offset:13824
buffer_load_dwordx4 v115, s[72:75], s51 offen offset:3072 lds
s_add_u32 m0, s55, 8192
s_add_u32 s50, s13, 65536
v_mfma_f32_16x16x32_bf16 v[176:179], a[0:3], a[28:31], v[176:179]
ds_read_b64_tr_b16 a[76:77], v127 offset:14336
s_add_u32 s51, s13, 65536
v_mfma_f32_16x16x32_bf16 v[180:183], a[4:7], a[28:31], v[180:183]
ds_read_b64_tr_b16 a[78:79], v127 offset:14848
buffer_load_dwordx4 v112, s[72:75], s50 offen offset:0 lds
v_mfma_f32_16x16x32_bf16 v[184:187], a[8:11], a[28:31], v[184:187]
ds_read_b64_tr_b16 a[80:81], v240 offset:14336
v_mfma_f32_16x16x32_bf16 v[188:191], a[12:15], a[28:31], v[188:191]
ds_read_b64_tr_b16 a[82:83], v240 offset:14848
buffer_load_dwordx4 v113, s[72:75], s50 offen offset:1024 lds
v_mfma_f32_16x16x32_bf16 v[192:195], a[0:3], a[32:35], v[192:195]
ds_read_b128 v[68:71], v16 offset:1024
v_mfma_f32_16x16x32_bf16 v[196:199], a[4:7], a[32:35], v[196:199]
buffer_load_dwordx4 v114, s[72:75], s51 offen offset:2048 lds
ds_read_b128 v[72:75], v16 offset:2048
v_mfma_f32_16x16x32_bf16 v[200:203], a[8:11], a[32:35], v[200:203]
ds_read_b128 v[76:79], v16 offset:3072
v_mfma_f32_16x16x32_bf16 v[204:207], a[12:15], a[32:35], v[204:207]
buffer_load_dwordx4 v115, s[72:75], s51 offen offset:3072 lds
ds_read_b128 v[80:83], v16 offset:4096
v_mfma_f32_16x16x32_bf16 v[208:211], a[0:3], a[36:39], v[208:211]
ds_read_b128 v[84:87], v16 offset:5120
v_mfma_f32_16x16x32_bf16 v[212:215], a[4:7], a[36:39], v[212:215]
v_mfma_f32_16x16x32_bf16 v[216:219], a[8:11], a[36:39], v[216:219]
v_mfma_f32_16x16x32_bf16 v[220:223], a[12:15], a[36:39], v[220:223]
s_waitcnt vmcnt(12) lgkmcnt(0)
s_barrier
v_mfma_f32_16x16x32_bf16 v[128:131], a[60:63], a[44:47], v[128:131]
ds_read_b64_tr_b16 a[112:113], v12 offset:0
v_mfma_f32_16x16x32_bf16 v[132:135], a[60:63], a[48:51], v[132:135]
ds_read_b64_tr_b16 a[114:115], v12 offset:2048
v_mfma_f32_16x16x32_bf16 v[136:139], a[60:63], a[52:55], v[136:139]
ds_read_b64_tr_b16 a[116:117], v13 offset:0
v_mfma_f32_16x16x32_bf16 v[140:143], a[60:63], a[56:59], v[140:143]
ds_read_b64_tr_b16 a[118:119], v13 offset:2048
v_mfma_f32_16x16x32_bf16 v[144:147], a[64:67], a[44:47], v[144:147]
ds_read_b64_tr_b16 a[120:121], v14 offset:0
v_mfma_f32_16x16x32_bf16 v[148:151], a[64:67], a[48:51], v[148:151]
ds_read_b64_tr_b16 a[122:123], v14 offset:2048
v_mfma_f32_16x16x32_bf16 v[152:155], a[64:67], a[52:55], v[152:155]
ds_read_b64_tr_b16 a[124:125], v15 offset:0
s_add_u32 m0, s55, 49152
v_mfma_f32_16x16x32_bf16 v[156:159], a[64:67], a[56:59], v[156:159]
ds_read_b64_tr_b16 a[126:127], v15 offset:2048
s_add_u32 s50, s14, 0
v_mfma_f32_16x16x32_bf16 v[160:163], a[44:47], a[68:71], v[160:163]
ds_read_b64_tr_b16 a[128:129], v12 offset:4096
s_add_u32 s51, s14, 0
v_mfma_f32_16x16x32_bf16 v[164:167], a[48:51], a[68:71], v[164:167]
ds_read_b64_tr_b16 a[130:131], v12 offset:6144
buffer_load_dwordx4 v112, s[72:75], s50 offen offset:0 lds
v_mfma_f32_16x16x32_bf16 v[168:171], a[52:55], a[68:71], v[168:171]
ds_read_b64_tr_b16 a[132:133], v13 offset:4096
v_mfma_f32_16x16x32_bf16 v[172:175], a[56:59], a[68:71], v[172:175]
ds_read_b64_tr_b16 a[134:135], v13 offset:6144
buffer_load_dwordx4 v113, s[72:75], s50 offen offset:1024 lds
v_mfma_f32_16x16x32_bf16 v[176:179], a[44:47], a[72:75], v[176:179]
ds_read_b64_tr_b16 a[136:137], v14 offset:4096
v_mfma_f32_16x16x32_bf16 v[180:183], a[48:51], a[72:75], v[180:183]
ds_read_b64_tr_b16 a[138:139], v14 offset:6144
buffer_load_dwordx4 v114, s[72:75], s51 offen offset:2048 lds
v_mfma_f32_16x16x32_bf16 v[184:187], a[52:55], a[72:75], v[184:187]
ds_read_b64_tr_b16 a[140:141], v15 offset:4096
v_mfma_f32_16x16x32_bf16 v[188:191], a[56:59], a[72:75], v[188:191]
ds_read_b64_tr_b16 a[142:143], v15 offset:6144
buffer_load_dwordx4 v115, s[72:75], s51 offen offset:3072 lds
s_add_u32 m0, s55, 53248
s_add_u32 s50, s14, 32768
v_mfma_f32_16x16x32_bf16 v[192:195], a[44:47], a[76:79], v[192:195]
ds_read_b64_tr_b16 a[144:145], v12 offset:8192
s_add_u32 s51, s14, 32768
v_mfma_f32_16x16x32_bf16 v[196:199], a[48:51], a[76:79], v[196:199]
ds_read_b64_tr_b16 a[146:147], v12 offset:10240
buffer_load_dwordx4 v112, s[72:75], s50 offen offset:0 lds
v_mfma_f32_16x16x32_bf16 v[200:203], a[52:55], a[76:79], v[200:203]
ds_read_b64_tr_b16 a[148:149], v13 offset:8192
v_mfma_f32_16x16x32_bf16 v[204:207], a[56:59], a[76:79], v[204:207]
ds_read_b64_tr_b16 a[150:151], v13 offset:10240
buffer_load_dwordx4 v113, s[72:75], s50 offen offset:1024 lds
v_mfma_f32_16x16x32_bf16 v[208:211], a[44:47], a[80:83], v[208:211]
ds_read_b64_tr_b16 a[152:153], v14 offset:8192
v_mfma_f32_16x16x32_bf16 v[212:215], a[48:51], a[80:83], v[212:215]
ds_read_b64_tr_b16 a[154:155], v14 offset:10240
v_mfma_f32_16x16x32_bf16 v[216:219], a[52:55], a[80:83], v[216:219]
ds_read_b64_tr_b16 a[156:157], v15 offset:8192
v_mfma_f32_16x16x32_bf16 v[220:223], a[56:59], a[80:83], v[220:223]
ds_read_b64_tr_b16 a[158:159], v15 offset:10240
buffer_load_dwordx4 v114, s[72:75], s51 offen offset:2048 lds
buffer_load_dwordx4 v115, s[72:75], s51 offen offset:3072 lds
s_add_u32 m0, s55, 57344
s_add_u32 s50, s14, 65536
s_add_u32 s51, s14, 65536
buffer_load_dwordx4 v112, s[72:75], s50 offen offset:0 lds
buffer_load_dwordx4 v113, s[72:75], s50 offen offset:1024 lds
buffer_load_dwordx4 v114, s[72:75], s51 offen offset:2048 lds
buffer_load_dwordx4 v115, s[72:75], s51 offen offset:3072 lds
s_mov_b32 s61, 0
L_cchkq:
v_min_u32 v18, v57, v59
v_max_u32 v19, v57, v59
v_min3_u32 v18, v18, v61, v63
v_max3_u32 v19, v19, v61, v63
v_min3_u32 v18, v18, v65, v69
v_max3_u32 v19, v19, v65, v69
v_min3_u32 v18, v18, v73, v77
v_max3_u32 v19, v19, v73, v77
v_min3_u32 v18, v18, v81, v85
v_max3_u32 v19, v19, v81, v85
v_min3_u32 v18, v18, v67, v71
v_max3_u32 v19, v19, v67, v71
v_min3_u32 v18, v18, v75, v79
v_max3_u32 v19, v19, v75, v79
v_min3_u32 v18, v18, v83, v87
v_max3_u32 v19, v19, v83, v87
v_cmp_ne_u32 vcc, s60, v18
v_cmp_ne_u32 s[62:63], s60, v19
s_or_b64 vcc, vcc, s[62:63]
s_cbranch_vccnz L_creq
L_cokq:
s_mov_b32 s62, 0x01000100
v_perm_b32 v32, v56, v56, s62
v_mov_b32 v33, 0
v_mov_b32 v35, 0
v_mov_b32 v34, v32
v_perm_b32 v36, v58, v58, s62
v_mov_b32 v37, 0
v_mov_b32 v39, 0
v_mov_b32 v38, v36
v_perm_b32 v40, v60, v60, s62
v_mov_b32 v41, 0
v_mov_b32 v43, 0
v_mov_b32 v42, v40
v_perm_b32 v44, v62, v62, s62
v_mov_b32 v45, 0
v_mov_b32 v47, 0
v_mov_b32 v46, v44
s_nop 1
v_mfma_f32_16x16x32_bf16 v[160:163], v[32:35], v[72:75], v[160:163]
v_and_b32 v48, 0xffff0000, v56
v_mfma_f32_16x16x32_bf16 v[164:167], v[36:39], v[72:75], v[164:167]
v_and_b32 v49, 0xffff0000, v58
v_mfma_f32_16x16x32_bf16 v[168:171], v[40:43], v[72:75], v[168:171]
v_and_b32 v50, 0xffff0000, v60
v_mfma_f32_16x16x32_bf16 v[172:175], v[44:47], v[72:75], v[172:175]
v_and_b32 v51, 0xffff0000, v62
v_mfma_f32_16x16x32_bf16 v[176:179], v[32:35], v[76:79], v[176:179]
v_rcp_f32 v48, v48
v_mfma_f32_16x16x32_bf16 v[180:183], v[36:39], v[76:79], v[180:183]
v_rcp_f32 v49, v49
v_mfma_f32_16x16x32_bf16 v[184:187], v[40:43], v[76:79], v[184:187]
v_rcp_f32 v50, v50
v_mfma_f32_16x16x32_bf16 v[188:191], v[44:47], v[76:79], v[188:191]
v_rcp_f32 v51, v51
v_mfma_f32_16x16x32_bf16 v[192:195], v[32:35], v[80:83], v[192:195]
v_mfma_f32_16x16x32_bf16 v[196:199], v[36:39], v[80:83], v[196:199]
v_mfma_f32_16x16x32_bf16 v[200:203], v[40:43], v[80:83], v[200:203]
v_mfma_f32_16x16x32_bf16 v[204:207], v[44:47], v[80:83], v[204:207]
v_mfma_f32_16x16x32_bf16 v[208:211], v[32:35], v[84:87], v[208:211]
v_mfma_f32_16x16x32_bf16 v[212:215], v[36:39], v[84:87], v[212:215]
v_mfma_f32_16x16x32_bf16 v[216:219], v[40:43], v[84:87], v[216:219]
v_mfma_f32_16x16x32_bf16 v[220:223], v[44:47], v[84:87], v[220:223]
v_mfma_f32_16x16x32_bf16 v[128:131], v[64:67], v[32:35], v[128:131]
v_mfma_f32_16x16x32_bf16 v[132:135], v[64:67], v[36:39], v[132:135]
v_mfma_f32_16x16x32_bf16 v[136:139], v[64:67], v[40:43], v[136:139]
v_mfma_f32_16x16x32_bf16 v[140:143], v[64:67], v[44:47], v[140:143]
v_mfma_f32_16x16x32_bf16 v[144:147], v[68:71], v[32:35], v[144:147]
v_mfma_f32_16x16x32_bf16 v[148:151], v[68:71], v[36:39], v[148:151]
v_mfma_f32_16x16x32_bf16 v[152:155], v[68:71], v[40:43], v[152:155]
v_mfma_f32_16x16x32_bf16 v[156:159], v[68:71], v[44:47], v[156:159]
s_lshl_b32 s62, s43, 1
s_add_u32 s62, s62, s41
s_lshl_b32 s63, s40, 8
s_add_u32 s63, s63, 147456
v_lshrrev_b32 v18, 1, v94
v_add_u32 v18, s63, v18
v_lshrrev_b32 v19, 4, v1
v_lshlrev_b32 v19, 4, v19
v_add_u32 v19, s63, v19
ds_write_b32 v18, v48 offset:0
ds_write_b32 v18, v49 offset:64
ds_write_b32 v18, v50 offset:128
ds_write_b32 v18, v51 offset:192
s_waitcnt lgkmcnt(0)
ds_read_b128 v[64:67], v19 offset:0
ds_read_b128 v[68:71], v19 offset:64
ds_read_b128 v[72:75], v19 offset:128
ds_read_b128 v[76:79], v19 offset:192
v_mov_b32 v24, 0x3fb8aa3b
v_mov_b32 v25, 0x3f317218
v_mov_b32 v26, 0x358637bd
v_mov_b32 v27, v26
v_mul_f32 v52, v24, v48
v_mul_f32 v53, v24, v49
v_mul_f32 v54, v24, v50
v_mul_f32 v55, v24, v51
s_waitcnt lgkmcnt(0)
v_pk_mul_f32 v[32:33], v[64:65], v[24:25] op_sel:[0,0] op_sel_hi:[1,0]
v_pk_mul_f32 v[34:35], v[66:67], v[24:25] op_sel:[0,0] op_sel_hi:[1,0]
v_pk_mul_f32 v[36:37], v[68:69], v[24:25] op_sel:[0,0] op_sel_hi:[1,0]
v_pk_mul_f32 v[38:39], v[70:71], v[24:25] op_sel:[0,0] op_sel_hi:[1,0]
v_pk_mul_f32 v[40:41], v[72:73], v[24:25] op_sel:[0,0] op_sel_hi:[1,0]
v_pk_mul_f32 v[42:43], v[74:75], v[24:25] op_sel:[0,0] op_sel_hi:[1,0]
v_pk_mul_f32 v[44:45], v[76:77], v[24:25] op_sel:[0,0] op_sel_hi:[1,0]
v_pk_mul_f32 v[46:47], v[78:79], v[24:25] op_sel:[0,0] op_sel_hi:[1,0]
v_mov_b32 v2, v95
v_pk_mul_f32 v[160:161], v[160:161], v[32:33]
v_pk_mul_f32 v[162:163], v[162:163], v[34:35]
v_exp_f32_e64 v20, v160 clamp
v_exp_f32_e64 v21, v161 clamp
v_exp_f32_e64 v22, v162 clamp
v_exp_f32_e64 v23, v163 clamp
v_max_f32 v160, 0, v160
v_max_f32 v161, 0, v161
v_max_f32 v162, 0, v162
v_max_f32 v163, 0, v163
v_pk_fma_f32 v[160:161], v[160:161], v[24:25], v[20:21] op_sel:[0,1,0] op_sel_hi:[1,1,1]
v_pk_fma_f32 v[162:163], v[162:163], v[24:25], v[22:23] op_sel:[0,1,0] op_sel_hi:[1,1,1]
v_pk_add_f32 v[160:161], v[160:161], v[26:27]
v_pk_add_f32 v[162:163], v[162:163], v[26:27]
v_cvt_pk_bf16_f32 v160, v160, v161
v_cvt_pk_bf16_f32 v161, v162, v163
v_pk_mul_f32 v[192:193], v[192:193], v[64:65]
v_pk_mul_f32 v[194:195], v[194:195], v[66:67]
v_cvt_pk_bf16_f32 v192, v192, v193
v_cvt_pk_bf16_f32 v193, v194, v195
v_pk_mul_f32 v[164:165], v[164:165], v[36:37]
v_pk_mul_f32 v[166:167], v[166:167], v[38:39]
v_exp_f32_e64 v20, v164 clamp
v_exp_f32_e64 v21, v165 clamp
v_exp_f32_e64 v22, v166 clamp
v_exp_f32_e64 v23, v167 clamp
v_max_f32 v164, 0, v164
v_max_f32 v165, 0, v165
v_max_f32 v166, 0, v166
v_max_f32 v167, 0, v167
v_pk_fma_f32 v[164:165], v[164:165], v[24:25], v[20:21] op_sel:[0,1,0] op_sel_hi:[1,1,1]
v_pk_fma_f32 v[166:167], v[166:167], v[24:25], v[22:23] op_sel:[0,1,0] op_sel_hi:[1,1,1]
v_pk_add_f32 v[164:165], v[164:165], v[26:27]
v_pk_add_f32 v[166:167], v[166:167], v[26:27]
v_cvt_pk_bf16_f32 v162, v164, v165
v_cvt_pk_bf16_f32 v163, v166, v167
v_pk_mul_f32 v[196:197], v[196:197], v[68:69]
v_pk_mul_f32 v[198:199], v[198:199], v[70:71]
v_cvt_pk_bf16_f32 v194, v196, v197
v_cvt_pk_bf16_f32 v195, v198, v199
v_pk_mul_f32 v[168:169], v[168:169], v[40:41]
v_pk_mul_f32 v[170:171], v[170:171], v[42:43]
v_exp_f32_e64 v20, v168 clamp
v_exp_f32_e64 v21, v169 clamp
v_exp_f32_e64 v22, v170 clamp
v_exp_f32_e64 v23, v171 clamp
v_max_f32 v168, 0, v168
v_max_f32 v169, 0, v169
v_max_f32 v170, 0, v170
v_max_f32 v171, 0, v171
v_pk_fma_f32 v[168:169], v[168:169], v[24:25], v[20:21] op_sel:[0,1,0] op_sel_hi:[1,1,1]
v_pk_fma_f32 v[170:171], v[170:171], v[24:25], v[22:23] op_sel:[0,1,0] op_sel_hi:[1,1,1]
v_pk_add_f32 v[168:169], v[168:169], v[26:27]
v_pk_add_f32 v[170:171], v[170:171], v[26:27]
v_cvt_pk_bf16_f32 v168, v168, v169
v_cvt_pk_bf16_f32 v169, v170, v171
v_pk_mul_f32 v[200:201], v[200:201], v[72:73]
v_pk_mul_f32 v[202:203], v[202:203], v[74:75]
v_cvt_pk_bf16_f32 v200, v200, v201
v_cvt_pk_bf16_f32 v201, v202, v203
v_pk_mul_f32 v[172:173], v[172:173], v[44:45]
v_pk_mul_f32 v[174:175], v[174:175], v[46:47]
v_exp_f32_e64 v20, v172 clamp
v_exp_f32_e64 v21, v173 clamp
v_exp_f32_e64 v22, v174 clamp
v_exp_f32_e64 v23, v175 clamp
v_max_f32 v172, 0, v172
v_max_f32 v173, 0, v173
v_max_f32 v174, 0, v174
v_max_f32 v175, 0, v175
v_pk_fma_f32 v[172:173], v[172:173], v[24:25], v[20:21] op_sel:[0,1,0] op_sel_hi:[1,1,1]
v_pk_fma_f32 v[174:175], v[174:175], v[24:25], v[22:23] op_sel:[0,1,0] op_sel_hi:[1,1,1]
v_pk_add_f32 v[172:173], v[172:173], v[26:27]
v_pk_add_f32 v[174:175], v[174:175], v[26:27]
v_cvt_pk_bf16_f32 v170, v172, v173
v_cvt_pk_bf16_f32 v171, v174, v175
v_pk_mul_f32 v[204:205], v[204:205], v[76:77]
v_pk_mul_f32 v[206:207], v[206:207], v[78:79]
v_cvt_pk_bf16_f32 v202, v204, v205
v_cvt_pk_bf16_f32 v203, v206, v207
s_nop 1
v_mfma_f32_16x16x32_bf16 v[80:83], v[160:163], v[192:195], 0
v_mfma_f32_16x16x32_bf16 v[84:87], v[160:163], v[28:31], 0
v_mfma_f32_16x16x32_bf16 v[80:83], v[168:171], v[200:203], v[80:83]
v_mfma_f32_16x16x32_bf16 v[84:87], v[168:171], v[28:31], v[84:87]
v_pk_mul_f32 v[176:177], v[176:177], v[32:33]
v_pk_mul_f32 v[178:179], v[178:179], v[34:35]
v_exp_f32_e64 v20, v176 clamp
v_exp_f32_e64 v21, v177 clamp
v_exp_f32_e64 v22, v178 clamp
v_exp_f32_e64 v23, v179 clamp
v_max_f32 v176, 0, v176
v_max_f32 v177, 0, v177
v_max_f32 v178, 0, v178
v_max_f32 v179, 0, v179
v_pk_fma_f32 v[176:177], v[176:177], v[24:25], v[20:21] op_sel:[0,1,0] op_sel_hi:[1,1,1]
v_pk_fma_f32 v[178:179], v[178:179], v[24:25], v[22:23] op_sel:[0,1,0] op_sel_hi:[1,1,1]
v_pk_add_f32 v[176:177], v[176:177], v[26:27]
v_pk_add_f32 v[178:179], v[178:179], v[26:27]
v_cvt_pk_bf16_f32 v176, v176, v177
v_cvt_pk_bf16_f32 v177, v178, v179
v_pk_mul_f32 v[208:209], v[208:209], v[64:65]
v_pk_mul_f32 v[210:211], v[210:211], v[66:67]
v_cvt_pk_bf16_f32 v208, v208, v209
v_cvt_pk_bf16_f32 v209, v210, v211
v_pk_mul_f32 v[180:181], v[180:181], v[36:37]
v_pk_mul_f32 v[182:183], v[182:183], v[38:39]
v_exp_f32_e64 v20, v180 clamp
v_exp_f32_e64 v21, v181 clamp
v_exp_f32_e64 v22, v182 clamp
v_exp_f32_e64 v23, v183 clamp
v_max_f32 v180, 0, v180
v_max_f32 v181, 0, v181
v_max_f32 v182, 0, v182
v_max_f32 v183, 0, v183
v_pk_fma_f32 v[180:181], v[180:181], v[24:25], v[20:21] op_sel:[0,1,0] op_sel_hi:[1,1,1]
v_pk_fma_f32 v[182:183], v[182:183], v[24:25], v[22:23] op_sel:[0,1,0] op_sel_hi:[1,1,1]
v_pk_add_f32 v[180:181], v[180:181], v[26:27]
v_pk_add_f32 v[182:183], v[182:183], v[26:27]
v_cvt_pk_bf16_f32 v178, v180, v181
v_cvt_pk_bf16_f32 v179, v182, v183
v_pk_mul_f32 v[212:213], v[212:213], v[68:69]
v_pk_mul_f32 v[214:215], v[214:215], v[70:71]
v_cvt_pk_bf16_f32 v210, v212, v213
v_cvt_pk_bf16_f32 v211, v214, v215
v_pk_mul_f32 v[184:185], v[184:185], v[40:41]
v_pk_mul_f32 v[186:187], v[186:187], v[42:43]
v_exp_f32_e64 v20, v184 clamp
v_exp_f32_e64 v21, v185 clamp
v_exp_f32_e64 v22, v186 clamp
v_exp_f32_e64 v23, v187 clamp
v_max_f32 v184, 0, v184
v_max_f32 v185, 0, v185
v_max_f32 v186, 0, v186
v_max_f32 v187, 0, v187
v_pk_fma_f32 v[184:185], v[184:185], v[24:25], v[20:21] op_sel:[0,1,0] op_sel_hi:[1,1,1]
v_pk_fma_f32 v[186:187], v[186:187], v[24:25], v[22:23] op_sel:[0,1,0] op_sel_hi:[1,1,1]
v_pk_add_f32 v[184:185], v[184:185], v[26:27]
v_pk_add_f32 v[186:187], v[186:187], v[26:27]
v_cvt_pk_bf16_f32 v184, v184, v185
v_cvt_pk_bf16_f32 v185, v186, v187
v_pk_mul_f32 v[216:217], v[216:217], v[72:73]
v_pk_mul_f32 v[218:219], v[218:219], v[74:75]
v_cvt_pk_bf16_f32 v216, v216, v217
v_cvt_pk_bf16_f32 v217, v218, v219
v_pk_mul_f32 v[188:189], v[188:189], v[44:45]
v_pk_mul_f32 v[190:191], v[190:191], v[46:47]
v_exp_f32_e64 v20, v188 clamp
v_exp_f32_e64 v21, v189 clamp
v_exp_f32_e64 v22, v190 clamp
v_exp_f32_e64 v23, v191 clamp
v_max_f32 v188, 0, v188
v_max_f32 v189, 0, v189
v_max_f32 v190, 0, v190
v_max_f32 v191, 0, v191
v_pk_fma_f32 v[188:189], v[188:189], v[24:25], v[20:21] op_sel:[0,1,0] op_sel_hi:[1,1,1]
v_pk_fma_f32 v[190:191], v[190:191], v[24:25], v[22:23] op_sel:[0,1,0] op_sel_hi:[1,1,1]
v_pk_add_f32 v[188:189], v[188:189], v[26:27]
v_pk_add_f32 v[190:191], v[190:191], v[26:27]
v_cvt_pk_bf16_f32 v186, v188, v189
v_cvt_pk_bf16_f32 v187, v190, v191
v_pk_mul_f32 v[220:221], v[220:221], v[76:77]
v_pk_mul_f32 v[222:223], v[222:223], v[78:79]
v_cvt_pk_bf16_f32 v218, v220, v221
v_cvt_pk_bf16_f32 v219, v222, v223
s_nop 1
v_mfma_f32_16x16x32_bf16 v[88:91], v[176:179], v[208:211], 0
v_mfma_f32_16x16x32_bf16 v[92:95], v[176:179], v[28:31], 0
v_mfma_f32_16x16x32_bf16 v[88:91], v[184:187], v[216:219], v[88:91]
v_mfma_f32_16x16x32_bf16 v[92:95], v[184:187], v[28:31], v[92:95]
s_lshl_b32 s63, s40, 11
s_add_u32 s63, s63, 149504
v_add_u32 v18, s63, v2
s_xor_b32 s63, s40, 2
s_lshl_b32 s63, s63, 11
s_add_u32 s63, s63, 149504
v_add_u32 v19, s63, v2
s_nop 7
s_cmp_eq_u32 s41, 0
s_cbranch_scc1 L_nosw
v_swap_b32 v80, v88
v_swap_b32 v81, v89
v_swap_b32 v82, v90
v_swap_b32 v83, v91
v_swap_b32 v84, v92
v_swap_b32 v85, v93
v_swap_b32 v86, v94
v_swap_b32 v87, v95
L_nosw:
ds_write_b128 v18, v[88:91]
ds_write_b128 v18, v[92:95] offset:1024
s_waitcnt lgkmcnt(0)
s_barrier
ds_read_b128 v[88:91], v19
ds_read_b128 v[92:95], v19 offset:1024
s_lshl_b32 s64, s44, 1
s_add_u32 s64, s64, s42
s_lshl_b32 s64, s64, 1
s_add_u32 s64, s64, s41
s_lshl_b32 s65, s64, 4
s_add_u32 s65, s65, s43
s_lshl_b32 s66, s65, 11
s_add_u32 s66, s66, 11534336
s_lshl_b32 s67, s65, 7
s_add_u32 s67, s67, 917504
v_lshrrev_b32 v3, 4, v1
v_and_b32 v16, 1, v1
v_lshlrev_b32 v16, 4, v16
v_lshl_add_u32 v16, v3, 5, v16
s_mov_b32 vcc_lo, 0xaaaaaaaa
s_mov_b32 vcc_hi, 0xaaaaaaaa
v_mov_b32 v97, s60
v_mov_b32 v99, s60
s_waitcnt lgkmcnt(0)
v_pk_add_f32 v[80:81], v[80:81], v[88:89]
v_pk_add_f32 v[82:83], v[82:83], v[90:91]
v_pk_add_f32 v[84:85], v[84:85], v[92:93]
v_pk_add_f32 v[86:87], v[86:87], v[94:95]
v_mov_b32 v88, v82
v_mov_b32 v90, v83
v_mov_b32 v82, v81
v_mov_b32 v81, s60
v_mov_b32 v83, s60
v_mov_b32 v89, s60
v_mov_b32 v91, s60
v_cndmask_b32 v96, v84, v86, vcc
v_cndmask_b32 v98, v85, v87, vcc
buffer_store_dwordx4 v[80:83], v2, s[24:27], s66 offen sc1
buffer_store_dwordx4 v[88:91], v2, s[24:27], s66 offen offset:1024 sc1
s_mov_b32 exec_lo, 0x30003
s_mov_b32 exec_hi, 0x30003
buffer_store_dwordx4 v[96:99], v16, s[24:27], s67 offen sc1
s_mov_b64 exec, -1
s_lshl_b32 s67, s62, 3
s_add_u32 s67, s67, s44
s_lshl_b32 s67, s67, 1
s_add_u32 s67, s67, s42
s_lshl_b32 s67, s67, 12
s_add_u32 s67, s67, 8388608
v_pk_mul_f32 v[128:129], v[128:129], v[52:53] op_sel:[0,0] op_sel_hi:[1,0]
v_pk_mul_f32 v[130:131], v[130:131], v[52:53] op_sel:[0,0] op_sel_hi:[1,0]
v_exp_f32_e64 v20, v128 clamp
v_exp_f32_e64 v21, v129 clamp
v_exp_f32_e64 v22, v130 clamp
v_exp_f32_e64 v23, v131 clamp
v_max_f32 v128, 0, v128
v_max_f32 v129, 0, v129
v_max_f32 v130, 0, v130
v_max_f32 v131, 0, v131
v_pk_fma_f32 v[128:129], v[128:129], v[24:25], v[20:21] op_sel:[0,1,0] op_sel_hi:[1,1,1]
v_pk_fma_f32 v[130:131], v[130:131], v[24:25], v[22:23] op_sel:[0,1,0] op_sel_hi:[1,1,1]
v_pk_add_f32 v[128:129], v[128:129], v[26:27]
v_pk_add_f32 v[130:131], v[130:131], v[26:27]
v_cvt_pk_bf16_f32 v56, v128, v129
v_cvt_pk_bf16_f32 v57, v130, v131
v_pk_mul_f32 v[144:145], v[144:145], v[52:53] op_sel:[0,0] op_sel_hi:[1,0]
v_pk_mul_f32 v[146:147], v[146:147], v[52:53] op_sel:[0,0] op_sel_hi:[1,0]
v_exp_f32_e64 v20, v144 clamp
v_exp_f32_e64 v21, v145 clamp
v_exp_f32_e64 v22, v146 clamp
v_exp_f32_e64 v23, v147 clamp
v_max_f32 v144, 0, v144
v_max_f32 v145, 0, v145
v_max_f32 v146, 0, v146
v_max_f32 v147, 0, v147
v_pk_fma_f32 v[144:145], v[144:145], v[24:25], v[20:21] op_sel:[0,1,0] op_sel_hi:[1,1,1]
v_pk_fma_f32 v[146:147], v[146:147], v[24:25], v[22:23] op_sel:[0,1,0] op_sel_hi:[1,1,1]
v_pk_add_f32 v[144:145], v[144:145], v[26:27]
v_pk_add_f32 v[146:147], v[146:147], v[26:27]
v_cvt_pk_bf16_f32 v58, v144, v145
v_cvt_pk_bf16_f32 v59, v146, v147
buffer_store_dwordx4 v[56:59], v2, s[24:27], s67 offen offset:0 sc1
v_pk_mul_f32 v[132:133], v[132:133], v[52:53] op_sel:[0,1] op_sel_hi:[1,1]
v_pk_mul_f32 v[134:135], v[134:135], v[52:53] op_sel:[0,1] op_sel_hi:[1,1]
v_exp_f32_e64 v20, v132 clamp
v_exp_f32_e64 v21, v133 clamp
v_exp_f32_e64 v22, v134 clamp
v_exp_f32_e64 v23, v135 clamp
v_max_f32 v132, 0, v132
v_max_f32 v133, 0, v133
v_max_f32 v134, 0, v134
v_max_f32 v135, 0, v135
v_pk_fma_f32 v[132:133], v[132:133], v[24:25], v[20:21] op_sel:[0,1,0] op_sel_hi:[1,1,1]
v_pk_fma_f32 v[134:135], v[134:135], v[24:25], v[22:23] op_sel:[0,1,0] op_sel_hi:[1,1,1]
v_pk_add_f32 v[132:133], v[132:133], v[26:27]
v_pk_add_f32 v[134:135], v[134:135], v[26:27]
v_cvt_pk_bf16_f32 v60, v132, v133
v_cvt_pk_bf16_f32 v61, v134, v135
v_pk_mul_f32 v[148:149], v[148:149], v[52:53] op_sel:[0,1] op_sel_hi:[1,1]
v_pk_mul_f32 v[150:151], v[150:151], v[52:53] op_sel:[0,1] op_sel_hi:[1,1]
v_exp_f32_e64 v20, v148 clamp
v_exp_f32_e64 v21, v149 clamp
v_exp_f32_e64 v22, v150 clamp
v_exp_f32_e64 v23, v151 clamp
v_max_f32 v148, 0, v148
v_max_f32 v149, 0, v149
v_max_f32 v150, 0, v150
v_max_f32 v151, 0, v151
v_pk_fma_f32 v[148:149], v[148:149], v[24:25], v[20:21] op_sel:[0,1,0] op_sel_hi:[1,1,1]
v_pk_fma_f32 v[150:151], v[150:151], v[24:25], v[22:23] op_sel:[0,1,0] op_sel_hi:[1,1,1]
v_pk_add_f32 v[148:149], v[148:149], v[26:27]
v_pk_add_f32 v[150:151], v[150:151], v[26:27]
v_cvt_pk_bf16_f32 v62, v148, v149
v_cvt_pk_bf16_f32 v63, v150, v151
buffer_store_dwordx4 v[60:63], v2, s[24:27], s67 offen offset:1024 sc1
v_pk_mul_f32 v[136:137], v[136:137], v[54:55] op_sel:[0,0] op_sel_hi:[1,0]
v_pk_mul_f32 v[138:139], v[138:139], v[54:55] op_sel:[0,0] op_sel_hi:[1,0]
v_exp_f32_e64 v20, v136 clamp
v_exp_f32_e64 v21, v137 clamp
v_exp_f32_e64 v22, v138 clamp
v_exp_f32_e64 v23, v139 clamp
v_max_f32 v136, 0, v136
v_max_f32 v137, 0, v137
v_max_f32 v138, 0, v138
v_max_f32 v139, 0, v139
v_pk_fma_f32 v[136:137], v[136:137], v[24:25], v[20:21] op_sel:[0,1,0] op_sel_hi:[1,1,1]
v_pk_fma_f32 v[138:139], v[138:139], v[24:25], v[22:23] op_sel:[0,1,0] op_sel_hi:[1,1,1]
v_pk_add_f32 v[136:137], v[136:137], v[26:27]
v_pk_add_f32 v[138:139], v[138:139], v[26:27]
v_cvt_pk_bf16_f32 v64, v136, v137
v_cvt_pk_bf16_f32 v65, v138, v139
v_pk_mul_f32 v[152:153], v[152:153], v[54:55] op_sel:[0,0] op_sel_hi:[1,0]
v_pk_mul_f32 v[154:155], v[154:155], v[54:55] op_sel:[0,0] op_sel_hi:[1,0]
v_exp_f32_e64 v20, v152 clamp
v_exp_f32_e64 v21, v153 clamp
v_exp_f32_e64 v22, v154 clamp
v_exp_f32_e64 v23, v155 clamp
v_max_f32 v152, 0, v152
v_max_f32 v153, 0, v153
v_max_f32 v154, 0, v154
v_max_f32 v155, 0, v155
v_pk_fma_f32 v[152:153], v[152:153], v[24:25], v[20:21] op_sel:[0,1,0] op_sel_hi:[1,1,1]
v_pk_fma_f32 v[154:155], v[154:155], v[24:25], v[22:23] op_sel:[0,1,0] op_sel_hi:[1,1,1]
v_pk_add_f32 v[152:153], v[152:153], v[26:27]
v_pk_add_f32 v[154:155], v[154:155], v[26:27]
v_cvt_pk_bf16_f32 v66, v152, v153
v_cvt_pk_bf16_f32 v67, v154, v155
buffer_store_dwordx4 v[64:67], v2, s[24:27], s67 offen offset:2048 sc1
v_pk_mul_f32 v[140:141], v[140:141], v[54:55] op_sel:[0,1] op_sel_hi:[1,1]
v_pk_mul_f32 v[142:143], v[142:143], v[54:55] op_sel:[0,1] op_sel_hi:[1,1]
v_exp_f32_e64 v20, v140 clamp
v_exp_f32_e64 v21, v141 clamp
v_exp_f32_e64 v22, v142 clamp
v_exp_f32_e64 v23, v143 clamp
v_max_f32 v140, 0, v140
v_max_f32 v141, 0, v141
v_max_f32 v142, 0, v142
v_max_f32 v143, 0, v143
v_pk_fma_f32 v[140:141], v[140:141], v[24:25], v[20:21] op_sel:[0,1,0] op_sel_hi:[1,1,1]
v_pk_fma_f32 v[142:143], v[142:143], v[24:25], v[22:23] op_sel:[0,1,0] op_sel_hi:[1,1,1]
v_pk_add_f32 v[140:141], v[140:141], v[26:27]
v_pk_add_f32 v[142:143], v[142:143], v[26:27]
v_cvt_pk_bf16_f32 v68, v140, v141
v_cvt_pk_bf16_f32 v69, v142, v143
v_pk_mul_f32 v[156:157], v[156:157], v[54:55] op_sel:[0,1] op_sel_hi:[1,1]
v_pk_mul_f32 v[158:159], v[158:159], v[54:55] op_sel:[0,1] op_sel_hi:[1,1]
v_exp_f32_e64 v20, v156 clamp
v_exp_f32_e64 v21, v157 clamp
v_exp_f32_e64 v22, v158 clamp
v_exp_f32_e64 v23, v159 clamp
v_max_f32 v156, 0, v156
v_max_f32 v157, 0, v157
v_max_f32 v158, 0, v158
v_max_f32 v159, 0, v159
v_pk_fma_f32 v[156:157], v[156:157], v[24:25], v[20:21] op_sel:[0,1,0] op_sel_hi:[1,1,1]
v_pk_fma_f32 v[158:159], v[158:159], v[24:25], v[22:23] op_sel:[0,1,0] op_sel_hi:[1,1,1]
v_pk_add_f32 v[156:157], v[156:157], v[26:27]
v_pk_add_f32 v[158:159], v[158:159], v[26:27]
v_cvt_pk_bf16_f32 v70, v156, v157
v_cvt_pk_bf16_f32 v71, v158, v159
buffer_store_dwordx4 v[68:71], v2, s[24:27], s67 offen offset:3072 sc1
v_and_b32 v18, 15, v1
v_lshlrev_b32 v3, 4, v3
v_lshl_add_u32 v19, v18, 11, v3
v_and_b32 v20, 16, v3
v_lshl_add_u32 v18, v18, 7, v20
s_lshl_b32 s66, s64, 15
s_lshl_b32 s65, s43, 6
s_add_u32 s66, s66, s65
s_add_u32 s66, s66, 11534336
s_lshl_b32 s67, s64, 11
s_lshr_b32 s63, s43, 2
s_lshl_b32 s68, s63, 5
s_add_u32 s67, s67, s68
s_add_u32 s67, s67, 917504
s_lshl_b32 s68, s64, 10
s_add_u32 s68, s68, s65
s_add_u32 s68, s68, 983040
s_lshl_b32 s69, s64, 6
s_lshl_b32 s63, s63, 4
s_add_u32 s69, s69, s63
s_add_u32 s69, s69, 1015808
buffer_load_dwordx4 v[32:35], v19, s[24:27], s66 offen sc1
buffer_load_dwordx4 v[36:39], v19, s[24:27], s66 offen offset:1024 sc1
buffer_load_dwordx4 v[40:43], v18, s[24:27], s67 offen sc1
s_waitcnt vmcnt(10)
ds_read_b64_tr_b16 a[160:161], v4 offset:0
ds_read_b64_tr_b16 a[162:163], v4 offset:2048
ds_read_b64_tr_b16 a[164:165], v5 offset:0
ds_read_b64_tr_b16 a[166:167], v5 offset:2048
ds_read_b64_tr_b16 a[168:169], v6 offset:0
ds_read_b64_tr_b16 a[170:171], v6 offset:2048
ds_read_b64_tr_b16 a[172:173], v7 offset:0
ds_read_b64_tr_b16 a[174:175], v7 offset:2048
ds_read_b64_tr_b16 a[176:177], v4 offset:4096
ds_read_b64_tr_b16 a[178:179], v4 offset:6144
ds_read_b64_tr_b16 a[180:181], v5 offset:4096
ds_read_b64_tr_b16 a[182:183], v5 offset:6144
ds_read_b64_tr_b16 a[184:185], v6 offset:4096
ds_read_b64_tr_b16 a[186:187], v6 offset:6144
ds_read_b64_tr_b16 a[188:189], v7 offset:4096
ds_read_b64_tr_b16 a[190:191], v7 offset:6144
ds_read_b64_tr_b16 a[192:193], v4 offset:8192
ds_read_b64_tr_b16 a[194:195], v4 offset:10240
ds_read_b64_tr_b16 a[196:197], v5 offset:8192
ds_read_b64_tr_b16 a[198:199], v5 offset:10240
ds_read_b64_tr_b16 a[200:201], v6 offset:8192
ds_read_b64_tr_b16 a[202:203], v6 offset:10240
ds_read_b64_tr_b16 a[204:205], v7 offset:8192
ds_read_b64_tr_b16 a[206:207], v7 offset:10240
ds_read_b64_tr_b16 a[208:209], v8 offset:0
ds_read_b64_tr_b16 a[210:211], v8 offset:2048
ds_read_b64_tr_b16 a[212:213], v9 offset:0
ds_read_b64_tr_b16 a[214:215], v9 offset:2048
ds_read_b64_tr_b16 a[216:217], v10 offset:0
ds_read_b64_tr_b16 a[218:219], v10 offset:2048
ds_read_b64_tr_b16 a[220:221], v11 offset:0
ds_read_b64_tr_b16 a[222:223], v11 offset:2048
ds_read_b64_tr_b16 a[224:225], v8 offset:4096
ds_read_b64_tr_b16 a[226:227], v8 offset:6144
ds_read_b64_tr_b16 a[228:229], v9 offset:4096
ds_read_b64_tr_b16 a[230:231], v9 offset:6144
ds_read_b64_tr_b16 a[232:233], v10 offset:4096
ds_read_b64_tr_b16 a[234:235], v10 offset:6144
ds_read_b64_tr_b16 a[236:237], v11 offset:4096
ds_read_b64_tr_b16 a[238:239], v11 offset:6144
ds_read_b64_tr_b16 a[240:241], v8 offset:8192
ds_read_b64_tr_b16 a[242:243], v8 offset:10240
ds_read_b64_tr_b16 a[244:245], v9 offset:8192
ds_read_b64_tr_b16 a[246:247], v9 offset:10240
ds_read_b64_tr_b16 a[248:249], v10 offset:8192
ds_read_b64_tr_b16 a[250:251], v10 offset:10240
ds_read_b64_tr_b16 a[252:253], v11 offset:8192
ds_read_b64_tr_b16 a[254:255], v11 offset:10240
s_lshl_b32 s65, s62, 2
s_lshr_b32 s63, s44, 1
s_add_u32 s65, s65, s63
s_lshl_b32 s65, s65, 7
s_and_b32 s63, s44, 1
s_lshl_b32 s63, s63, 1
s_add_u32 s63, s63, s42
s_lshl_b32 s63, s63, 2
s_add_u32 s65, s65, s63
s_add_u32 s65, s65, 327696
s_waitcnt vmcnt(3)
s_mov_b64 exec, 1
v_mov_b32 v17, s60
v_mov_b32 v16, 0
buffer_store_dword v17, v16, s[24:27], s65 offen sc1
s_mov_b64 exec, -1
s_waitcnt vmcnt(1)
v_min3_u32 v44, v33, v35, v37
v_max3_u32 v45, v33, v35, v37
v_min3_u32 v44, v44, v39, v41
v_max3_u32 v45, v45, v39, v41
v_min_u32 v44, v44, v43
v_max_u32 v45, v45, v43
v_cmp_ne_u32 vcc, s60, v44
v_cmp_ne_u32 s[62:63], s60, v45
s_or_b64 vcc, vcc, s[62:63]
s_mov_b32 s61, 0
s_cbranch_vccz L_sl4
L_sl2:
buffer_load_dwordx4 v[32:35], v19, s[24:27], s66 offen sc1
buffer_load_dwordx4 v[36:39], v19, s[24:27], s66 offen offset:1024 sc1
buffer_load_dwordx4 v[40:43], v18, s[24:27], s67 offen sc1
s_waitcnt vmcnt(0)
v_min3_u32 v44, v33, v35, v37
v_max3_u32 v45, v33, v35, v37
v_min3_u32 v44, v44, v39, v41
v_max3_u32 v45, v45, v39, v41
v_min_u32 v44, v44, v43
v_max_u32 v45, v45, v43
v_cmp_ne_u32 vcc, s60, v44
v_cmp_ne_u32 s[62:63], s60, v45
s_or_b64 vcc, vcc, s[62:63]
s_cbranch_vccz L_sl4
s_add_u32 s61, s61, 1
s_cmp_lt_u32 s61, 20000
s_cbranch_scc1 L_sl2
L_sl4:
v_add_f32_dpp v32, v32, v32 row_ror:8 row_mask:0xf bank_mask:0xf
v_add_f32_dpp v34, v34, v34 row_ror:8 row_mask:0xf bank_mask:0xf
v_add_f32_dpp v36, v36, v36 row_ror:8 row_mask:0xf bank_mask:0xf
v_add_f32_dpp v38, v38, v38 row_ror:8 row_mask:0xf bank_mask:0xf
v_add_f32_dpp v40, v40, v40 row_ror:8 row_mask:0xf bank_mask:0xf
v_add_f32_dpp v42, v42, v42 row_ror:8 row_mask:0xf bank_mask:0xf
v_add_f32_dpp v32, v32, v32 row_ror:4 row_mask:0xf bank_mask:0xf
v_add_f32_dpp v34, v34, v34 row_ror:4 row_mask:0xf bank_mask:0xf
v_add_f32_dpp v36, v36, v36 row_ror:4 row_mask:0xf bank_mask:0xf
v_add_f32_dpp v38, v38, v38 row_ror:4 row_mask:0xf bank_mask:0xf
v_add_f32_dpp v40, v40, v40 row_ror:4 row_mask:0xf bank_mask:0xf
v_add_f32_dpp v42, v42, v42 row_ror:4 row_mask:0xf bank_mask:0xf
v_add_f32_dpp v32, v32, v32 row_ror:2 row_mask:0xf bank_mask:0xf
v_add_f32_dpp v34, v34, v34 row_ror:2 row_mask:0xf bank_mask:0xf
v_add_f32_dpp v36, v36, v36 row_ror:2 row_mask:0xf bank_mask:0xf
v_add_f32_dpp v38, v38, v38 row_ror:2 row_mask:0xf bank_mask:0xf
v_add_f32_dpp v40, v40, v40 row_ror:2 row_mask:0xf bank_mask:0xf
v_add_f32_dpp v42, v42, v42 row_ror:2 row_mask:0xf bank_mask:0xf
v_add_f32_dpp v32, v32, v32 row_ror:1 row_mask:0xf bank_mask:0xf
v_add_f32_dpp v34, v34, v34 row_ror:1 row_mask:0xf bank_mask:0xf
v_add_f32_dpp v36, v36, v36 row_ror:1 row_mask:0xf bank_mask:0xf
v_add_f32_dpp v38, v38, v38 row_ror:1 row_mask:0xf bank_mask:0xf
v_add_f32_dpp v40, v40, v40 row_ror:1 row_mask:0xf bank_mask:0xf
v_add_f32_dpp v42, v42, v42 row_ror:1 row_mask:0xf bank_mask:0xf
v_cvt_pk_bf16_f32 v32, v32, v34
v_cvt_pk_bf16_f32 v34, v36, v38
v_cvt_pk_bf16_f32 v40, v40, v42
v_lshrrev_b32 v20, 1, v20
s_mov_b32 exec_lo, 0x10001
s_mov_b32 exec_hi, 0x10001
buffer_store_dwordx4 v[32:35], v3, s[24:27], s68 offen sc1
s_and_b32 s63, s43, 3
s_cmp_eq_u32 s63, 0
s_cselect_b32 exec_lo, 0x10001, 0
s_mov_b32 exec_hi, 0
buffer_store_dwordx2 v[40:41], v20, s[24:27], s69 offen sc1
s_mov_b64 exec, -1
s_waitcnt lgkmcnt(0)
s_add_u32 m0, s55, 98304
s_add_u32 s50, s15, 0
s_add_u32 s51, s15, 0
buffer_load_dwordx4 v112, s[72:75], s50 offen offset:0 lds
buffer_load_dwordx4 v113, s[72:75], s50 offen offset:1024 lds
buffer_load_dwordx4 v114, s[72:75], s51 offen offset:2048 lds
buffer_load_dwordx4 v115, s[72:75], s51 offen offset:3072 lds
s_add_u32 m0, s55, 102400
s_add_u32 s50, s71, 0
s_add_u32 s51, s71, 0
buffer_load_dwordx4 v112, s[76:79], s50 offen offset:0 lds
buffer_load_dwordx4 v113, s[76:79], s50 offen offset:1024 lds
buffer_load_dwordx4 v114, s[76:79], s51 offen offset:2048 lds
buffer_load_dwordx4 v115, s[76:79], s51 offen offset:3072 lds
s_add_u32 m0, s55, 106496
s_add_u32 s50, s71, 32768
s_add_u32 s51, s71, 32768
buffer_load_dwordx4 v112, s[76:79], s50 offen offset:0 lds
buffer_load_dwordx4 v113, s[76:79], s50 offen offset:1024 lds
buffer_load_dwordx4 v114, s[76:79], s51 offen offset:2048 lds
buffer_load_dwordx4 v115, s[76:79], s51 offen offset:3072 lds
L_p2:
s_lshl_b32 s63, s46, 2
s_add_u32 s63, s63, s40
s_lshl_b32 s64, s63, 7
s_add_u32 s64, s64, 327680
v_and_b32 v16, 7, v1
v_lshlrev_b32 v16, 2, v16
buffer_load_dword v17, v16, s[24:27], s64 offen sc1
s_cmp_lg_u32 s45, 0
s_cbranch_scc1 L_p2q
s_waitcnt lgkmcnt(0)
s_add_u32 m0, s55, 98304
s_add_u32 s50, s15, 0
s_add_u32 s51, s15, 0
buffer_load_dwordx4 v112, s[72:75], s50 offen offset:0 lds
buffer_load_dwordx4 v113, s[72:75], s50 offen offset:1024 lds
buffer_load_dwordx4 v114, s[72:75], s51 offen offset:2048 lds
buffer_load_dwordx4 v115, s[72:75], s51 offen offset:3072 lds
s_add_u32 m0, s55, 102400
s_add_u32 s50, s71, 0
s_add_u32 s51, s71, 0
buffer_load_dwordx4 v112, s[76:79], s50 offen offset:0 lds
buffer_load_dwordx4 v113, s[76:79], s50 offen offset:1024 lds
buffer_load_dwordx4 v114, s[76:79], s51 offen offset:2048 lds
buffer_load_dwordx4 v115, s[76:79], s51 offen offset:3072 lds
s_add_u32 m0, s55, 106496
s_add_u32 s50, s71, 32768
s_add_u32 s51, s71, 32768
buffer_load_dwordx4 v112, s[76:79], s50 offen offset:0 lds
buffer_load_dwordx4 v113, s[76:79], s50 offen offset:1024 lds
buffer_load_dwordx4 v114, s[76:79], s51 offen offset:2048 lds
buffer_load_dwordx4 v115, s[76:79], s51 offen offset:3072 lds
L_p2q:
v_lshlrev_b32 v2, 4, v1
s_lshl_b32 s62, s40, 13
s_add_u32 s62, s62, 983040
s_add_u32 s49, s62, 4096
s_lshl_b32 s65, s40, 9
s_add_u32 s65, s65, 1015808
s_lshl_b32 s48, s63, 7
s_mul_i32 s66, s63, 57344
s_add_u32 s66, s66, 1048576
s_lshl_b32 s67, s63, 14
s_add_u32 s67, s67, 8388608
s_add_u32 s50, s3, 0
s_and_b32 s50, s50, 3
s_mul_i32 s50, s50, 14336
s_add_u32 s6, s50, s66
s_add_u32 s50, s3, 1
s_and_b32 s50, s50, 3
s_mul_i32 s50, s50, 14336
s_add_u32 s7, s50, s66
s_add_u32 s50, s3, 2
s_and_b32 s50, s50, 3
s_mul_i32 s50, s50, 14336
s_add_u32 s10, s50, s66
s_add_u32 s50, s3, 3
s_and_b32 s50, s50, 3
s_mul_i32 s50, s50, 14336
s_add_u32 s11, s50, s66
s_mul_i32 s51, s47, 7168
s_add_u32 s51, s51, s66
v_min_u32 v18, 55, v1
v_lshlrev_b32 v18, 7, v18
s_mov_b32 s61, 0
s_cmp_lg_u32 s45, 0
s_cbranch_scc1 L_p2w
s_waitcnt vmcnt(12)
s_branch L_p2c
L_p2w:
s_waitcnt vmcnt(0)
L_p2c:
v_cmp_ne_u32 vcc, s60, v17
s_cbranch_vccnz L_pqp
L_pqok:
s_waitcnt lgkmcnt(0)
buffer_load_dword v19, v18, s[24:27], s51 offen sc1
s_add_u32 s52, s6, 0
buffer_load_dwordx4 v[32:35], v2, s[24:27], s52 offen offset:0 sc1
buffer_load_dwordx4 v[36:39], v2, s[24:27], s52 offen offset:1024 sc1
buffer_load_dwordx4 v[40:43], v2, s[24:27], s52 offen offset:2048 sc1
buffer_load_dwordx4 v[44:47], v2, s[24:27], s52 offen offset:3072 sc1
s_add_u32 s52, s6, 4096
buffer_load_dwordx4 v[48:51], v2, s[24:27], s52 offen offset:0 sc1
buffer_load_dwordx4 v[52:55], v2, s[24:27], s52 offen offset:1024 sc1
buffer_load_dwordx4 v[56:59], v2, s[24:27], s52 offen offset:2048 sc1
buffer_load_dwordx4 v[60:63], v2, s[24:27], s52 offen offset:3072 sc1
s_add_u32 s52, s6, 8192
buffer_load_dwordx4 v[64:67], v2, s[24:27], s52 offen offset:0 sc1
buffer_load_dwordx4 v[68:71], v2, s[24:27], s52 offen offset:1024 sc1
buffer_load_dwordx4 v[72:75], v2, s[24:27], s52 offen offset:2048 sc1
buffer_load_dwordx4 v[76:79], v2, s[24:27], s52 offen offset:3072 sc1
s_add_u32 s52, s7, 0
buffer_load_dwordx4 v[80:83], v2, s[24:27], s52 offen offset:0 sc1
buffer_load_dwordx4 v[84:87], v2, s[24:27], s52 offen offset:1024 sc1
buffer_load_dwordx4 v[88:91], v2, s[24:27], s52 offen offset:2048 sc1
buffer_load_dwordx4 v[92:95], v2, s[24:27], s52 offen offset:3072 sc1
s_mov_b32 s16, s4
s_mov_b32 s17, s5
s_mov_b32 s18, 0x200000
s_mov_b32 s19, 0x20000
s_mov_b32 s32, s36
s_mov_b32 s33, s37
s_mov_b32 s34, 0x200000
s_mov_b32 s35, 0x20000
s_lshl_b32 s68, s63, 14
s_lshl_b32 s64, s47, 7
s_add_u32 s68, s68, s64
s_add_u32 s69, s68, 8192
v_lshrrev_b32 v24, 3, v1
v_and_b32 v25, 7, v1
v_lshlrev_b32 v26, 4, v25
v_lshl_add_u32 v3, v24, 10, v26
v_add_u32 v20, s55, v2
v_add_u32 v21, 98304, v20
v_and_b32 v16, 15, v1
v_lshrrev_b32 v27, 4, v1
v_mul_u32_u24 v16, 144, v16
v_lshl_add_u32 v16, v27, 3, v16
s_add_u32 s64, s55, 8192
v_add_u32 v16, s64, v16
v_mul_u32_u24 v17, 144, v24
v_add3_u32 v17, v17, v26, s64
v_and_b32 v0, 15, v1
v_lshlrev_b32 v0, 3, v0
v_and_b32 v23, 7, v1
v_lshlrev_b32 v23, 6, v23
v_lshrrev_b32 v22, 4, v1
v_lshl_add_u32 v23, v22, 4, v23
s_lshl_b32 s64, s40, 12
s_add_u32 s56, s64, 98304
s_add_u32 s57, s64, 49152
s_cmp_eq_u32 s40, 3
s_cselect_b32 s56, 4096, s56
s_cselect_b32 s57, 0, s57
v_add_u32 v22, s56, v2
v_mov_b32 v24, 0x358637bd
v_mov_b32 v25, 0x358637bd
v_mov_b32 v26, 0x358637bd
v_mov_b32 v27, 0x358637bd
s_waitcnt vmcnt(12)
v_mfma_f32_16x16x32_bf16 a[0:3], a[112:115], v[32:35], 0
s_add_u32 s52, s7, 4096
v_mfma_f32_16x16x32_bf16 a[4:7], a[112:115], v[36:39], 0
v_mfma_f32_16x16x32_bf16 a[8:11], a[112:115], v[40:43], 0
v_mfma_f32_16x16x32_bf16 a[12:15], a[112:115], v[44:47], 0
buffer_load_dwordx4 v[96:99], v2, s[24:27], s52 offen offset:0 sc1
v_mfma_f32_16x16x32_bf16 a[16:19], a[116:119], v[32:35], 0
v_mfma_f32_16x16x32_bf16 a[20:23], a[116:119], v[36:39], 0
v_mfma_f32_16x16x32_bf16 a[24:27], a[116:119], v[40:43], 0
buffer_load_dwordx4 v[100:103], v2, s[24:27], s52 offen offset:1024 sc1
v_mfma_f32_16x16x32_bf16 a[28:31], a[116:119], v[44:47], 0
v_mfma_f32_16x16x32_bf16 a[32:35], a[120:123], v[32:35], 0
v_mfma_f32_16x16x32_bf16 a[36:39], a[120:123], v[36:39], 0
buffer_load_dwordx4 v[104:107], v2, s[24:27], s52 offen offset:2048 sc1
v_mfma_f32_16x16x32_bf16 a[40:43], a[120:123], v[40:43], 0
v_mfma_f32_16x16x32_bf16 a[44:47], a[120:123], v[44:47], 0
v_mfma_f32_16x16x32_bf16 a[48:51], a[124:127], v[32:35], 0
buffer_load_dwordx4 v[108:111], v2, s[24:27], s52 offen offset:3072 sc1
v_mfma_f32_16x16x32_bf16 a[52:55], a[124:127], v[36:39], 0
v_mfma_f32_16x16x32_bf16 a[56:59], a[124:127], v[40:43], 0
v_mfma_f32_16x16x32_bf16 a[60:63], a[124:127], v[44:47], 0
s_waitcnt vmcnt(12)
v_mfma_f32_16x16x32_bf16 a[0:3], a[128:131], v[48:51], a[0:3]
s_add_u32 s52, s7, 8192
v_mfma_f32_16x16x32_bf16 a[4:7], a[128:131], v[52:55], a[4:7]
v_mfma_f32_16x16x32_bf16 a[8:11], a[128:131], v[56:59], a[8:11]
v_mfma_f32_16x16x32_bf16 a[12:15], a[128:131], v[60:63], a[12:15]
buffer_load_dwordx4 v[112:115], v2, s[24:27], s52 offen offset:0 sc1
v_mfma_f32_16x16x32_bf16 a[16:19], a[132:135], v[48:51], a[16:19]
v_mfma_f32_16x16x32_bf16 a[20:23], a[132:135], v[52:55], a[20:23]
v_mfma_f32_16x16x32_bf16 a[24:27], a[132:135], v[56:59], a[24:27]
buffer_load_dwordx4 v[116:119], v2, s[24:27], s52 offen offset:1024 sc1
v_mfma_f32_16x16x32_bf16 a[28:31], a[132:135], v[60:63], a[28:31]
v_mfma_f32_16x16x32_bf16 a[32:35], a[136:139], v[48:51], a[32:35]
v_mfma_f32_16x16x32_bf16 a[36:39], a[136:139], v[52:55], a[36:39]
buffer_load_dwordx4 v[120:123], v2, s[24:27], s52 offen offset:2048 sc1
v_mfma_f32_16x16x32_bf16 a[40:43], a[136:139], v[56:59], a[40:43]
v_mfma_f32_16x16x32_bf16 a[44:47], a[136:139], v[60:63], a[44:47]
v_mfma_f32_16x16x32_bf16 a[48:51], a[140:143], v[48:51], a[48:51]
buffer_load_dwordx4 v[124:127], v2, s[24:27], s52 offen offset:3072 sc1
v_mfma_f32_16x16x32_bf16 a[52:55], a[140:143], v[52:55], a[52:55]
v_mfma_f32_16x16x32_bf16 a[56:59], a[140:143], v[56:59], a[56:59]
v_mfma_f32_16x16x32_bf16 a[60:63], a[140:143], v[60:63], a[60:63]
s_waitcnt vmcnt(12)
v_mfma_f32_16x16x32_bf16 a[0:3], a[144:147], v[64:67], a[0:3]
s_add_u32 s52, s10, 0
v_mfma_f32_16x16x32_bf16 a[4:7], a[144:147], v[68:71], a[4:7]
buffer_load_dwordx4 v[32:35], v2, s[24:27], s52 offen offset:0 sc1
v_mfma_f32_16x16x32_bf16 a[8:11], a[144:147], v[72:75], a[8:11]
buffer_load_dwordx4 v[36:39], v2, s[24:27], s52 offen offset:1024 sc1
v_mfma_f32_16x16x32_bf16 a[12:15], a[144:147], v[76:79], a[12:15]
buffer_load_dwordx4 v[40:43], v2, s[24:27], s52 offen offset:2048 sc1
v_mfma_f32_16x16x32_bf16 a[16:19], a[148:151], v[64:67], a[16:19]
buffer_load_dwordx4 v[44:47], v2, s[24:27], s52 offen offset:3072 sc1
v_mfma_f32_16x16x32_bf16 a[20:23], a[148:151], v[68:71], a[20:23]
buffer_load_dwordx4 v[192:195], v2, s[24:27], s62 offen offset:0 sc1
v_mfma_f32_16x16x32_bf16 a[24:27], a[148:151], v[72:75], a[24:27]
buffer_load_dwordx4 v[196:199], v2, s[24:27], s62 offen offset:1024 sc1
v_mfma_f32_16x16x32_bf16 a[28:31], a[148:151], v[76:79], a[28:31]
buffer_load_dwordx4 v[200:203], v2, s[24:27], s62 offen offset:2048 sc1
v_mfma_f32_16x16x32_bf16 a[32:35], a[152:155], v[64:67], a[32:35]
buffer_load_dwordx4 v[204:207], v2, s[24:27], s62 offen offset:3072 sc1
v_mfma_f32_16x16x32_bf16 a[36:39], a[152:155], v[68:71], a[36:39]
buffer_load_dwordx4 v[208:211], v2, s[24:27], s49 offen offset:0 sc1
v_mfma_f32_16x16x32_bf16 a[40:43], a[152:155], v[72:75], a[40:43]
buffer_load_dwordx4 v[212:215], v2, s[24:27], s49 offen offset:1024 sc1
v_mfma_f32_16x16x32_bf16 a[44:47], a[152:155], v[76:79], a[44:47]
buffer_load_dwordx4 v[216:219], v2, s[24:27], s49 offen offset:2048 sc1
v_mfma_f32_16x16x32_bf16 a[48:51], a[156:159], v[64:67], a[48:51]
buffer_load_dwordx4 v[220:223], v2, s[24:27], s49 offen offset:3072 sc1
v_mfma_f32_16x16x32_bf16 a[52:55], a[156:159], v[68:71], a[52:55]
buffer_load_dwordx4 v[28:31], v23, s[24:27], s65 offen sc1
v_mfma_f32_16x16x32_bf16 a[56:59], a[156:159], v[72:75], a[56:59]
buffer_load_dwordx2 v[18:19], v0, s[24:27], s48 offen sc1
v_mfma_f32_16x16x32_bf16 a[60:63], a[156:159], v[76:79], a[60:63]
s_waitcnt vmcnt(22)
v_mfma_f32_16x16x32_bf16 a[0:3], a[160:163], v[80:83], a[0:3]
s_add_u32 s52, s67, 0
v_mfma_f32_16x16x32_bf16 a[4:7], a[160:163], v[84:87], a[4:7]
v_mfma_f32_16x16x32_bf16 a[8:11], a[160:163], v[88:91], a[8:11]
v_mfma_f32_16x16x32_bf16 a[12:15], a[160:163], v[92:95], a[12:15]
buffer_load_dwordx4 v[128:131], v2, s[24:27], s52 offen offset:0 sc1
v_mfma_f32_16x16x32_bf16 a[16:19], a[164:167], v[80:83], a[16:19]
v_mfma_f32_16x16x32_bf16 a[20:23], a[164:167], v[84:87], a[20:23]
v_mfma_f32_16x16x32_bf16 a[24:27], a[164:167], v[88:91], a[24:27]
buffer_load_dwordx4 v[132:135], v2, s[24:27], s52 offen offset:1024 sc1
v_mfma_f32_16x16x32_bf16 a[28:31], a[164:167], v[92:95], a[28:31]
v_mfma_f32_16x16x32_bf16 a[32:35], a[168:171], v[80:83], a[32:35]
v_mfma_f32_16x16x32_bf16 a[36:39], a[168:171], v[84:87], a[36:39]
buffer_load_dwordx4 v[136:139], v2, s[24:27], s52 offen offset:2048 sc1
v_mfma_f32_16x16x32_bf16 a[40:43], a[168:171], v[88:91], a[40:43]
v_mfma_f32_16x16x32_bf16 a[44:47], a[168:171], v[92:95], a[44:47]
v_mfma_f32_16x16x32_bf16 a[48:51], a[172:175], v[80:83], a[48:51]
buffer_load_dwordx4 v[140:143], v2, s[24:27], s52 offen offset:3072 sc1
v_mfma_f32_16x16x32_bf16 a[52:55], a[172:175], v[84:87], a[52:55]
v_mfma_f32_16x16x32_bf16 a[56:59], a[172:175], v[88:91], a[56:59]
v_mfma_f32_16x16x32_bf16 a[60:63], a[172:175], v[92:95], a[60:63]
s_waitcnt vmcnt(22)
v_mfma_f32_16x16x32_bf16 a[0:3], a[176:179], v[96:99], a[0:3]
s_add_u32 s52, s10, 4096
v_mfma_f32_16x16x32_bf16 a[4:7], a[176:179], v[100:103], a[4:7]
buffer_load_dwordx4 v[48:51], v2, s[24:27], s52 offen offset:0 sc1
v_mfma_f32_16x16x32_bf16 a[8:11], a[176:179], v[104:107], a[8:11]
v_mfma_f32_16x16x32_bf16 a[12:15], a[176:179], v[108:111], a[12:15]
buffer_load_dwordx4 v[52:55], v2, s[24:27], s52 offen offset:1024 sc1
v_mfma_f32_16x16x32_bf16 a[16:19], a[180:183], v[96:99], a[16:19]
buffer_load_dwordx4 v[56:59], v2, s[24:27], s52 offen offset:2048 sc1
v_mfma_f32_16x16x32_bf16 a[20:23], a[180:183], v[100:103], a[20:23]
v_mfma_f32_16x16x32_bf16 a[24:27], a[180:183], v[104:107], a[24:27]
buffer_load_dwordx4 v[60:63], v2, s[24:27], s52 offen offset:3072 sc1
v_mfma_f32_16x16x32_bf16 a[28:31], a[180:183], v[108:111], a[28:31]
v_mfma_f32_16x16x32_bf16 a[32:35], a[184:187], v[96:99], a[32:35]
s_add_u32 s52, s10, 8192
v_mfma_f32_16x16x32_bf16 a[36:39], a[184:187], v[100:103], a[36:39]
buffer_load_dwordx4 v[64:67], v2, s[24:27], s52 offen offset:0 sc1
v_mfma_f32_16x16x32_bf16 a[40:43], a[184:187], v[104:107], a[40:43]
v_mfma_f32_16x16x32_bf16 a[44:47], a[184:187], v[108:111], a[44:47]
buffer_load_dwordx4 v[68:71], v2, s[24:27], s52 offen offset:1024 sc1
v_mfma_f32_16x16x32_bf16 a[48:51], a[188:191], v[96:99], a[48:51]
buffer_load_dwordx4 v[72:75], v2, s[24:27], s52 offen offset:2048 sc1
v_mfma_f32_16x16x32_bf16 a[52:55], a[188:191], v[100:103], a[52:55]
v_mfma_f32_16x16x32_bf16 a[56:59], a[188:191], v[104:107], a[56:59]
buffer_load_dwordx4 v[76:79], v2, s[24:27], s52 offen offset:3072 sc1
v_mfma_f32_16x16x32_bf16 a[60:63], a[188:191], v[108:111], a[60:63]
s_waitcnt vmcnt(26)
v_mfma_f32_16x16x32_bf16 a[0:3], a[192:195], v[112:115], a[0:3]
s_add_u32 s52, s11, 0
v_mfma_f32_16x16x32_bf16 a[4:7], a[192:195], v[116:119], a[4:7]
buffer_load_dwordx4 v[80:83], v2, s[24:27], s52 offen offset:0 sc1
v_mfma_f32_16x16x32_bf16 a[8:11], a[192:195], v[120:123], a[8:11]
v_mfma_f32_16x16x32_bf16 a[12:15], a[192:195], v[124:127], a[12:15]
buffer_load_dwordx4 v[84:87], v2, s[24:27], s52 offen offset:1024 sc1
v_mfma_f32_16x16x32_bf16 a[16:19], a[196:199], v[112:115], a[16:19]
buffer_load_dwordx4 v[88:91], v2, s[24:27], s52 offen offset:2048 sc1
v_mfma_f32_16x16x32_bf16 a[20:23], a[196:199], v[116:119], a[20:23]
v_mfma_f32_16x16x32_bf16 a[24:27], a[196:199], v[120:123], a[24:27]
buffer_load_dwordx4 v[92:95], v2, s[24:27], s52 offen offset:3072 sc1
v_mfma_f32_16x16x32_bf16 a[28:31], a[196:199], v[124:127], a[28:31]
v_mfma_f32_16x16x32_bf16 a[32:35], a[200:203], v[112:115], a[32:35]
s_add_u32 s52, s67, 4096
v_mfma_f32_16x16x32_bf16 a[36:39], a[200:203], v[116:119], a[36:39]
buffer_load_dwordx4 v[144:147], v2, s[24:27], s52 offen offset:0 sc1
v_mfma_f32_16x16x32_bf16 a[40:43], a[200:203], v[120:123], a[40:43]
v_mfma_f32_16x16x32_bf16 a[44:47], a[200:203], v[124:127], a[44:47]
buffer_load_dwordx4 v[148:151], v2, s[24:27], s52 offen offset:1024 sc1
v_mfma_f32_16x16x32_bf16 a[48:51], a[204:207], v[112:115], a[48:51]
buffer_load_dwordx4 v[152:155], v2, s[24:27], s52 offen offset:2048 sc1
v_mfma_f32_16x16x32_bf16 a[52:55], a[204:207], v[116:119], a[52:55]
v_mfma_f32_16x16x32_bf16 a[56:59], a[204:207], v[120:123], a[56:59]
buffer_load_dwordx4 v[156:159], v2, s[24:27], s52 offen offset:3072 sc1
v_mfma_f32_16x16x32_bf16 a[60:63], a[204:207], v[124:127], a[60:63]
s_waitcnt vmcnt(16)
v_mfma_f32_16x16x32_bf16 a[0:3], a[208:211], v[32:35], a[0:3]
v_min3_u32 v224, v193, v195, v197
v_max3_u32 v225, v193, v195, v197
v_min3_u32 v224, v224, v199, v201
s_add_u32 s52, s67, 8192
v_mfma_f32_16x16x32_bf16 a[4:7], a[208:211], v[36:39], a[4:7]
v_max3_u32 v225, v225, v199, v201
v_min3_u32 v224, v224, v203, v205
v_max3_u32 v225, v225, v203, v205
v_mfma_f32_16x16x32_bf16 a[8:11], a[208:211], v[40:43], a[8:11]
v_min3_u32 v224, v224, v207, v209
v_max3_u32 v225, v225, v207, v209
v_min3_u32 v224, v224, v211, v213
v_mfma_f32_16x16x32_bf16 a[12:15], a[208:211], v[44:47], a[12:15]
v_max3_u32 v225, v225, v211, v213
v_min3_u32 v224, v224, v215, v217
v_max3_u32 v225, v225, v215, v217
buffer_load_dwordx4 v[160:163], v2, s[24:27], s52 offen offset:0 sc1
v_mfma_f32_16x16x32_bf16 a[16:19], a[212:215], v[32:35], a[16:19]
v_min3_u32 v224, v224, v219, v221
v_max3_u32 v225, v225, v219, v221
v_min3_u32 v224, v224, v223, v29
v_mfma_f32_16x16x32_bf16 a[20:23], a[212:215], v[36:39], a[20:23]
v_max3_u32 v225, v225, v223, v29
v_min3_u32 v224, v224, v31, v19
v_max3_u32 v225, v225, v31, v19
v_mfma_f32_16x16x32_bf16 a[24:27], a[212:215], v[40:43], a[24:27]
v_cmp_ne_u32 vcc, s60, v224
v_cmp_ne_u32 s[58:59], s60, v225
buffer_load_dwordx4 v[164:167], v2, s[24:27], s52 offen offset:1024 sc1
v_mfma_f32_16x16x32_bf16 a[28:31], a[212:215], v[44:47], a[28:31]
s_or_b64 vcc, vcc, s[58:59]
s_mov_b32 s61, 0
s_cbranch_vccnz L_kfre
L_kfok:
v_mfma_f32_16x16x32_bf16 a[32:35], a[216:219], v[32:35], a[32:35]
v_mov_b32 v193, v194
v_mov_b32_dpp v194, v28 row_newbcast:0 row_mask:0xf bank_mask:0xf
v_mov_b32_dpp v195, v30 row_newbcast:0 row_mask:0xf bank_mask:0xf
v_mov_b32 v197, v198
v_mfma_f32_16x16x32_bf16 a[36:39], a[216:219], v[36:39], a[36:39]
v_mov_b32_dpp v198, v28 row_newbcast:1 row_mask:0xf bank_mask:0xf
v_mov_b32_dpp v199, v30 row_newbcast:1 row_mask:0xf bank_mask:0xf
v_mov_b32 v201, v202
v_mov_b32_dpp v202, v28 row_newbcast:2 row_mask:0xf bank_mask:0xf
buffer_load_dwordx4 v[168:171], v2, s[24:27], s52 offen offset:2048 sc1
v_mfma_f32_16x16x32_bf16 a[40:43], a[216:219], v[40:43], a[40:43]
v_mov_b32_dpp v203, v30 row_newbcast:2 row_mask:0xf bank_mask:0xf
v_mov_b32 v205, v206
v_mov_b32_dpp v206, v28 row_newbcast:3 row_mask:0xf bank_mask:0xf
v_mov_b32_dpp v207, v30 row_newbcast:3 row_mask:0xf bank_mask:0xf
v_mfma_f32_16x16x32_bf16 a[44:47], a[216:219], v[44:47], a[44:47]
v_mov_b32 v209, v210
v_mov_b32_dpp v210, v28 row_newbcast:4 row_mask:0xf bank_mask:0xf
v_mov_b32_dpp v211, v30 row_newbcast:4 row_mask:0xf bank_mask:0xf
v_mov_b32 v213, v214
v_mfma_f32_16x16x32_bf16 a[48:51], a[220:223], v[32:35], a[48:51]
v_mov_b32_dpp v214, v28 row_newbcast:5 row_mask:0xf bank_mask:0xf
v_mov_b32_dpp v215, v30 row_newbcast:5 row_mask:0xf bank_mask:0xf
v_mov_b32 v217, v218
v_mov_b32_dpp v218, v28 row_newbcast:6 row_mask:0xf bank_mask:0xf
buffer_load_dwordx4 v[172:175], v2, s[24:27], s52 offen offset:3072 sc1
v_mfma_f32_16x16x32_bf16 a[52:55], a[220:223], v[36:39], a[52:55]
v_mov_b32_dpp v219, v30 row_newbcast:6 row_mask:0xf bank_mask:0xf
v_mov_b32 v221, v222
v_mov_b32_dpp v222, v28 row_newbcast:7 row_mask:0xf bank_mask:0xf
v_mov_b32_dpp v223, v30 row_newbcast:7 row_mask:0xf bank_mask:0xf
v_mfma_f32_16x16x32_bf16 a[56:59], a[220:223], v[40:43], a[56:59]
v_and_b32 v18, 0xffff0000, v18
v_add_u32 v23, s57, v2
v_mfma_f32_16x16x16_bf16 v[228:231], v[194:195], v[128:129], v[24:27]
v_mfma_f32_16x16x16_bf16 v[236:239], v[198:199], v[130:131], v[24:27]
v_mfma_f32_16x16x32_bf16 a[60:63], a[220:223], v[44:47], a[60:63]
v_rcp_f32 v18, v18
v_mfma_f32_16x16x16_bf16 v[224:227], v[192:193], v[128:129], 0
v_mfma_f32_16x16x16_bf16 v[232:235], v[196:197], v[130:131], 0
v_bfe_u32 v28, v1, 4, 2
v_lshlrev_b32 v28, 1, v28
v_and_b32 v29, 7, v1
v_xor_b32 v28, v28, v29
v_lshlrev_b32 v28, 4, v28
v_lshrrev_b32 v29, 3, v1
v_lshl_add_u32 v28, v29, 10, v28
v_add_u32 v29, 7168, v28
v_add_u32 v30, 14336, v28
v_add_u32 v31, 21504, v28
s_waitcnt vmcnt(16)
v_mfma_f32_16x16x32_bf16 a[0:3], a[224:227], v[48:51], a[0:3]
v_rcp_f32 v228, v228
v_mfma_f32_16x16x16_bf16 v[244:247], v[194:195], v[132:133], v[24:27]
v_rcp_f32 v236, v236
s_add_u32 m0, s55, 0
s_add_u32 s50, s71, 65536
v_mfma_f32_16x16x32_bf16 a[4:7], a[224:227], v[52:55], a[4:7]
v_mul_f32 v224, v224, v228
v_mul_f32 v225, v225, v228
v_mfma_f32_16x16x16_bf16 v[252:255], v[198:199], v[134:135], v[24:27]
s_add_u32 s51, s71, 65536
v_mfma_f32_16x16x32_bf16 a[8:11], a[224:227], v[56:59], a[8:11]
v_mul_f32 v226, v226, v228
v_mul_f32 v227, v227, v228
buffer_load_dwordx4 v28, s[76:79], s50 offen offset:0 lds
v_mfma_f32_16x16x32_bf16 a[12:15], a[224:227], v[60:63], a[12:15]
v_mul_f32 v232, v232, v236
v_mul_f32 v233, v233, v236
v_mfma_f32_16x16x16_bf16 v[240:243], v[192:193], v[132:133], 0
v_mul_f32 v234, v234, v236
v_mul_f32 v235, v235, v236
buffer_load_dwordx4 v29, s[76:79], s50 offen offset:1024 lds
buffer_load_dwordx4 v30, s[76:79], s51 offen offset:2048 lds
v_mfma_f32_16x16x32_bf16 a[16:19], a[228:231], v[48:51], a[16:19]
v_cvt_pk_bf16_f32 v128, v224, v225
v_cvt_pk_bf16_f32 v129, v226, v227
v_mfma_f32_16x16x16_bf16 v[248:251], v[196:197], v[134:135], 0
buffer_load_dwordx4 v31, s[76:79], s51 offen offset:3072 lds
v_mfma_f32_16x16x32_bf16 a[20:23], a[228:231], v[52:55], a[20:23]
v_cvt_pk_bf16_f32 v130, v232, v233
v_cvt_pk_bf16_f32 v131, v234, v235
s_add_u32 m0, s55, 4096
v_mfma_f32_16x16x32_bf16 a[24:27], a[228:231], v[56:59], a[24:27]
v_rcp_f32 v244, v244
v_mfma_f32_16x16x16_bf16 v[228:231], v[194:195], v[136:137], v[24:27]
v_rcp_f32 v252, v252
s_add_u32 s50, s71, 98304
s_add_u32 s51, s71, 98304
v_mfma_f32_16x16x32_bf16 a[28:31], a[228:231], v[60:63], a[28:31]
v_mul_f32 v240, v240, v244
v_mul_f32 v241, v241, v244
v_mfma_f32_16x16x16_bf16 v[236:239], v[198:199], v[138:139], v[24:27]
buffer_load_dwordx4 v28, s[76:79], s50 offen offset:0 lds
v_mfma_f32_16x16x32_bf16 a[32:35], a[232:235], v[48:51], a[32:35]
v_mul_f32 v242, v242, v244
v_mul_f32 v243, v243, v244
buffer_load_dwordx4 v29, s[76:79], s50 offen offset:1024 lds
v_mfma_f32_16x16x32_bf16 a[36:39], a[232:235], v[52:55], a[36:39]
v_mul_f32 v248, v248, v252
v_mul_f32 v249, v249, v252
v_mfma_f32_16x16x16_bf16 v[224:227], v[192:193], v[136:137], 0
v_mul_f32 v250, v250, v252
v_mul_f32 v251, v251, v252
buffer_load_dwordx4 v30, s[76:79], s51 offen offset:2048 lds
buffer_load_dwordx4 v31, s[76:79], s51 offen offset:3072 lds
v_mfma_f32_16x16x32_bf16 a[40:43], a[232:235], v[56:59], a[40:43]
v_cvt_pk_bf16_f32 v132, v240, v241
v_cvt_pk_bf16_f32 v133, v242, v243
v_mfma_f32_16x16x16_bf16 v[232:235], v[196:197], v[138:139], 0
s_add_u32 m0, s55, 8192
v_mfma_f32_16x16x32_bf16 a[44:47], a[232:235], v[60:63], a[44:47]
v_cvt_pk_bf16_f32 v134, v248, v249
v_cvt_pk_bf16_f32 v135, v250, v251
s_add_u32 s50, s15, 32768
v_mfma_f32_16x16x32_bf16 a[48:51], a[236:239], v[48:51], a[48:51]
v_rcp_f32 v228, v228
v_mfma_f32_16x16x16_bf16 v[244:247], v[194:195], v[140:141], v[24:27]
v_rcp_f32 v236, v236
s_add_u32 s51, s15, 32768
buffer_load_dwordx4 v28, s[72:75], s50 offen offset:0 lds
v_mfma_f32_16x16x32_bf16 a[52:55], a[236:239], v[52:55], a[52:55]
v_mul_f32 v224, v224, v228
v_mul_f32 v225, v225, v228
v_mfma_f32_16x16x16_bf16 v[252:255], v[198:199], v[142:143], v[24:27]
buffer_load_dwordx4 v29, s[72:75], s50 offen offset:1024 lds
v_mfma_f32_16x16x32_bf16 a[56:59], a[236:239], v[56:59], a[56:59]
v_mul_f32 v226, v226, v228
v_mul_f32 v227, v227, v228
buffer_load_dwordx4 v30, s[72:75], s51 offen offset:2048 lds
v_mfma_f32_16x16x32_bf16 a[60:63], a[236:239], v[60:63], a[60:63]
v_mul_f32 v232, v232, v236
v_mul_f32 v233, v233, v236
v_mfma_f32_16x16x16_bf16 v[240:243], v[192:193], v[140:141], 0
v_mul_f32 v234, v234, v236
v_mul_f32 v235, v235, v236
buffer_load_dwordx4 v31, s[72:75], s51 offen offset:3072 lds
s_waitcnt vmcnt(16)
v_mfma_f32_16x16x32_bf16 a[0:3], a[240:243], v[64:67], a[0:3]
v_cvt_pk_bf16_f32 v136, v224, v225
v_cvt_pk_bf16_f32 v137, v226, v227
v_mfma_f32_16x16x16_bf16 v[248:251], v[196:197], v[142:143], 0
ds_read_b64_tr_b16 a[144:145], v12 offset:0
s_add_u32 s52, s67, 12288
v_mfma_f32_16x16x32_bf16 a[4:7], a[240:243], v[68:71], a[4:7]
v_cvt_pk_bf16_f32 v138, v232, v233
v_cvt_pk_bf16_f32 v139, v234, v235
v_mfma_f32_16x16x32_bf16 a[8:11], a[240:243], v[72:75], a[8:11]
v_rcp_f32 v244, v244
v_mfma_f32_16x16x16_bf16 v[228:231], v[202:203], v[144:145], v[24:27]
v_rcp_f32 v252, v252
ds_read_b64_tr_b16 a[146:147], v12 offset:2048
v_mfma_f32_16x16x32_bf16 a[12:15], a[240:243], v[76:79], a[12:15]
v_mul_f32 v240, v240, v244
v_mul_f32 v241, v241, v244
v_mfma_f32_16x16x16_bf16 v[236:239], v[206:207], v[146:147], v[24:27]
buffer_load_dwordx4 v[176:179], v2, s[24:27], s52 offen offset:0 sc1
v_mfma_f32_16x16x32_bf16 a[16:19], a[244:247], v[64:67], a[16:19]
v_mul_f32 v242, v242, v244
v_mul_f32 v243, v243, v244
ds_read_b64_tr_b16 a[148:149], v13 offset:0
v_mfma_f32_16x16x32_bf16 a[20:23], a[244:247], v[68:71], a[20:23]
v_mul_f32 v248, v248, v252
v_mul_f32 v249, v249, v252
v_mfma_f32_16x16x16_bf16 v[224:227], v[200:201], v[144:145], 0
v_mul_f32 v250, v250, v252
v_mul_f32 v251, v251, v252
v_mfma_f32_16x16x32_bf16 a[24:27], a[244:247], v[72:75], a[24:27]
v_cvt_pk_bf16_f32 v140, v240, v241
v_cvt_pk_bf16_f32 v141, v242, v243
v_mfma_f32_16x16x16_bf16 v[232:235], v[204:205], v[146:147], 0
ds_read_b64_tr_b16 a[150:151], v13 offset:2048
buffer_load_dwordx4 v[180:183], v2, s[24:27], s52 offen offset:1024 sc1
v_mfma_f32_16x16x32_bf16 a[28:31], a[244:247], v[76:79], a[28:31]
v_cvt_pk_bf16_f32 v142, v248, v249
v_cvt_pk_bf16_f32 v143, v250, v251
v_mfma_f32_16x16x32_bf16 a[32:35], a[248:251], v[64:67], a[32:35]
v_rcp_f32 v228, v228
v_mfma_f32_16x16x16_bf16 v[244:247], v[202:203], v[148:149], v[24:27]
v_rcp_f32 v236, v236
ds_read_b64_tr_b16 a[152:153], v14 offset:0
v_mfma_f32_16x16x32_bf16 a[36:39], a[248:251], v[68:71], a[36:39]
v_mul_f32 v224, v224, v228
v_mul_f32 v225, v225, v228
v_mfma_f32_16x16x16_bf16 v[252:255], v[206:207], v[150:151], v[24:27]
buffer_load_dwordx4 v[184:187], v2, s[24:27], s52 offen offset:2048 sc1
v_mfma_f32_16x16x32_bf16 a[40:43], a[248:251], v[72:75], a[40:43]
v_mul_f32 v226, v226, v228
v_mul_f32 v227, v227, v228
ds_read_b64_tr_b16 a[154:155], v14 offset:2048
v_mfma_f32_16x16x32_bf16 a[44:47], a[248:251], v[76:79], a[44:47]
v_mul_f32 v232, v232, v236
v_mul_f32 v233, v233, v236
v_mfma_f32_16x16x16_bf16 v[240:243], v[200:201], v[148:149], 0
v_mul_f32 v234, v234, v236
v_mul_f32 v235, v235, v236
v_mfma_f32_16x16x32_bf16 a[48:51], a[252:255], v[64:67], a[48:51]
v_cvt_pk_bf16_f32 v144, v224, v225
v_cvt_pk_bf16_f32 v145, v226, v227
v_mfma_f32_16x16x16_bf16 v[248:251], v[204:205], v[150:151], 0
ds_read_b64_tr_b16 a[156:157], v15 offset:0
buffer_load_dwordx4 v[188:191], v2, s[24:27], s52 offen offset:3072 sc1
v_mfma_f32_16x16x32_bf16 a[52:55], a[252:255], v[68:71], a[52:55]
v_cvt_pk_bf16_f32 v146, v232, v233
v_cvt_pk_bf16_f32 v147, v234, v235
v_mfma_f32_16x16x32_bf16 a[56:59], a[252:255], v[72:75], a[56:59]
v_rcp_f32 v244, v244
v_mfma_f32_16x16x16_bf16 v[228:231], v[202:203], v[152:153], v[24:27]
v_rcp_f32 v252, v252
ds_read_b64_tr_b16 a[158:159], v15 offset:2048
v_mfma_f32_16x16x32_bf16 a[60:63], a[252:255], v[76:79], a[60:63]
v_mul_f32 v240, v240, v244
v_mul_f32 v241, v241, v244
v_mfma_f32_16x16x16_bf16 v[236:239], v[206:207], v[154:155], v[24:27]
s_waitcnt vmcnt(16) lgkmcnt(0)
v_mfma_f32_16x16x32_bf16 a[0:3], a[144:147], v[80:83], a[0:3]
v_mul_f32 v242, v242, v244
v_mul_f32 v243, v243, v244
ds_read_b64_tr_b16 a[128:129], v12 offset:4096
s_add_u32 m0, s55, 49152
s_add_u32 s50, s15, 65536
v_mfma_f32_16x16x32_bf16 a[4:7], a[144:147], v[84:87], a[4:7]
v_mul_f32 v248, v248, v252
v_mul_f32 v249, v249, v252
v_mfma_f32_16x16x16_bf16 v[224:227], v[200:201], v[152:153], 0
v_mul_f32 v250, v250, v252
v_mul_f32 v251, v251, v252
s_add_u32 s51, s15, 65536
v_mfma_f32_16x16x32_bf16 a[8:11], a[144:147], v[88:91], a[8:11]
v_cvt_pk_bf16_f32 v148, v240, v241
v_cvt_pk_bf16_f32 v149, v242, v243
v_mfma_f32_16x16x16_bf16 v[232:235], v[204:205], v[154:155], 0
ds_read_b64_tr_b16 a[130:131], v12 offset:6144
buffer_load_dwordx4 v28, s[72:75], s50 offen offset:0 lds
v_mfma_f32_16x16x32_bf16 a[12:15], a[144:147], v[92:95], a[12:15]
v_cvt_pk_bf16_f32 v150, v248, v249
v_cvt_pk_bf16_f32 v151, v250, v251
buffer_load_dwordx4 v29, s[72:75], s50 offen offset:1024 lds
buffer_load_dwordx4 v30, s[72:75], s51 offen offset:2048 lds
v_mfma_f32_16x16x32_bf16 a[16:19], a[148:151], v[80:83], a[16:19]
v_rcp_f32 v228, v228
v_mfma_f32_16x16x16_bf16 v[244:247], v[202:203], v[156:157], v[24:27]
v_rcp_f32 v236, v236
ds_read_b64_tr_b16 a[132:133], v13 offset:4096
buffer_load_dwordx4 v31, s[72:75], s51 offen offset:3072 lds
v_mfma_f32_16x16x32_bf16 a[20:23], a[148:151], v[84:87], a[20:23]
v_mul_f32 v224, v224, v228
v_mul_f32 v225, v225, v228
v_mfma_f32_16x16x16_bf16 v[252:255], v[206:207], v[158:159], v[24:27]
s_add_u32 m0, s55, 53248
v_mfma_f32_16x16x32_bf16 a[24:27], a[148:151], v[88:91], a[24:27]
v_mul_f32 v226, v226, v228
v_mul_f32 v227, v227, v228
ds_read_b64_tr_b16 a[134:135], v13 offset:6144
s_add_u32 s50, s70, 98304
s_add_u32 s51, s70, 196608
v_mfma_f32_16x16x32_bf16 a[28:31], a[148:151], v[92:95], a[28:31]
v_mul_f32 v232, v232, v236
v_mul_f32 v233, v233, v236
v_mfma_f32_16x16x16_bf16 v[240:243], v[200:201], v[156:157], 0
v_mul_f32 v234, v234, v236
v_mul_f32 v235, v235, v236
buffer_load_dwordx4 v28, s[72:75], s50 offen offset:0 lds
v_mfma_f32_16x16x32_bf16 a[32:35], a[152:155], v[80:83], a[32:35]
v_cvt_pk_bf16_f32 v152, v224, v225
v_cvt_pk_bf16_f32 v153, v226, v227
v_mfma_f32_16x16x16_bf16 v[248:251], v[204:205], v[158:159], 0
ds_read_b64_tr_b16 a[136:137], v14 offset:4096
buffer_load_dwordx4 v29, s[72:75], s50 offen offset:1024 lds
v_mfma_f32_16x16x32_bf16 a[36:39], a[152:155], v[84:87], a[36:39]
v_cvt_pk_bf16_f32 v154, v232, v233
v_cvt_pk_bf16_f32 v155, v234, v235
buffer_load_dwordx4 v30, s[72:75], s51 offen offset:2048 lds
buffer_load_dwordx4 v31, s[72:75], s51 offen offset:3072 lds
v_mfma_f32_16x16x32_bf16 a[40:43], a[152:155], v[88:91], a[40:43]
v_rcp_f32 v244, v244
v_mfma_f32_16x16x16_bf16 v[228:231], v[210:211], v[160:161], v[24:27]
v_rcp_f32 v252, v252
ds_read_b64_tr_b16 a[138:139], v14 offset:6144
s_add_u32 m0, s55, 57344
v_mfma_f32_16x16x32_bf16 a[44:47], a[152:155], v[92:95], a[44:47]
v_mul_f32 v240, v240, v244
v_mul_f32 v241, v241, v244
v_mfma_f32_16x16x16_bf16 v[236:239], v[214:215], v[162:163], v[24:27]
s_add_u32 s50, s70, 327680
v_mfma_f32_16x16x32_bf16 a[48:51], a[156:159], v[80:83], a[48:51]
v_mul_f32 v242, v242, v244
v_mul_f32 v243, v243, v244
ds_read_b64_tr_b16 a[140:141], v15 offset:4096
s_add_u32 s51, s70, 425984
buffer_load_dwordx4 v28, s[72:75], s50 offen offset:0 lds
v_mfma_f32_16x16x32_bf16 a[52:55], a[156:159], v[84:87], a[52:55]
v_mul_f32 v248, v248, v252
v_mul_f32 v249, v249, v252
v_mfma_f32_16x16x16_bf16 v[224:227], v[208:209], v[160:161], 0
v_mul_f32 v250, v250, v252
v_mul_f32 v251, v251, v252
buffer_load_dwordx4 v29, s[72:75], s50 offen offset:1024 lds
v_mfma_f32_16x16x32_bf16 a[56:59], a[156:159], v[88:91], a[56:59]
v_cvt_pk_bf16_f32 v156, v240, v241
v_cvt_pk_bf16_f32 v157, v242, v243
v_mfma_f32_16x16x16_bf16 v[232:235], v[212:213], v[162:163], 0
ds_read_b64_tr_b16 a[142:143], v15 offset:6144
buffer_load_dwordx4 v30, s[72:75], s51 offen offset:2048 lds
v_mfma_f32_16x16x32_bf16 a[60:63], a[156:159], v[92:95], a[60:63]
v_cvt_pk_bf16_f32 v158, v248, v249
v_cvt_pk_bf16_f32 v159, v250, v251
buffer_load_dwordx4 v31, s[72:75], s51 offen offset:3072 lds
s_waitcnt lgkmcnt(0)
s_nop 1
v_mfma_f32_16x16x32_bf16 a[64:67], a[128:131], v[128:131], 0
v_rcp_f32 v228, v228
v_mfma_f32_16x16x16_bf16 v[244:247], v[210:211], v[164:165], v[24:27]
v_rcp_f32 v236, v236
ds_read_b64_tr_b16 a[144:145], v12 offset:8192
s_add_u32 s52, s11, 4096
v_mfma_f32_16x16x32_bf16 a[68:71], a[128:131], v[132:135], 0
v_mul_f32 v224, v224, v228
v_mul_f32 v225, v225, v228
v_mfma_f32_16x16x16_bf16 v[252:255], v[214:215], v[166:167], v[24:27]
v_mfma_f32_16x16x32_bf16 a[72:75], a[128:131], v[136:139], 0
v_mul_f32 v226, v226, v228
v_mul_f32 v227, v227, v228
ds_read_b64_tr_b16 a[146:147], v12 offset:10240
v_mfma_f32_16x16x32_bf16 a[76:79], a[128:131], v[140:143], 0
v_mul_f32 v232, v232, v236
v_mul_f32 v233, v233, v236
v_mfma_f32_16x16x16_bf16 v[240:243], v[208:209], v[164:165], 0
v_mul_f32 v234, v234, v236
v_mul_f32 v235, v235, v236
buffer_load_dwordx4 v[96:99], v2, s[24:27], s52 offen offset:0 sc1
v_mfma_f32_16x16x32_bf16 a[80:83], a[132:135], v[128:131], 0
v_cvt_pk_bf16_f32 v160, v224, v225
v_cvt_pk_bf16_f32 v161, v226, v227
v_mfma_f32_16x16x16_bf16 v[248:251], v[212:213], v[166:167], 0
ds_read_b64_tr_b16 a[148:149], v13 offset:8192
v_mfma_f32_16x16x32_bf16 a[84:87], a[132:135], v[132:135], 0
v_cvt_pk_bf16_f32 v162, v232, v233
v_cvt_pk_bf16_f32 v163, v234, v235
v_mfma_f32_16x16x32_bf16 a[88:91], a[132:135], v[136:139], 0
v_rcp_f32 v244, v244
v_mfma_f32_16x16x16_bf16 v[228:231], v[210:211], v[168:169], v[24:27]
v_rcp_f32 v252, v252
ds_read_b64_tr_b16 a[150:151], v13 offset:10240
buffer_load_dwordx4 v[100:103], v2, s[24:27], s52 offen offset:1024 sc1
v_mfma_f32_16x16x32_bf16 a[92:95], a[132:135], v[140:143], 0
v_mul_f32 v240, v240, v244
v_mul_f32 v241, v241, v244
v_mfma_f32_16x16x16_bf16 v[236:239], v[214:215], v[170:171], v[24:27]
v_mfma_f32_16x16x32_bf16 a[96:99], a[136:139], v[128:131], 0
v_mul_f32 v242, v242, v244
v_mul_f32 v243, v243, v244
ds_read_b64_tr_b16 a[152:153], v14 offset:8192
v_mfma_f32_16x16x32_bf16 a[100:103], a[136:139], v[132:135], 0
v_mul_f32 v248, v248, v252
v_mul_f32 v249, v249, v252
v_mfma_f32_16x16x16_bf16 v[224:227], v[208:209], v[168:169], 0
v_mul_f32 v250, v250, v252
v_mul_f32 v251, v251, v252
buffer_load_dwordx4 v[104:107], v2, s[24:27], s52 offen offset:2048 sc1
v_mfma_f32_16x16x32_bf16 a[104:107], a[136:139], v[136:139], 0
v_cvt_pk_bf16_f32 v164, v240, v241
v_cvt_pk_bf16_f32 v165, v242, v243
v_mfma_f32_16x16x16_bf16 v[232:235], v[212:213], v[170:171], 0
ds_read_b64_tr_b16 a[154:155], v14 offset:10240
v_mfma_f32_16x16x32_bf16 a[108:111], a[136:139], v[140:143], 0
v_cvt_pk_bf16_f32 v166, v248, v249
v_cvt_pk_bf16_f32 v167, v250, v251
v_mfma_f32_16x16x32_bf16 a[112:115], a[140:143], v[128:131], 0
v_rcp_f32 v228, v228
v_mfma_f32_16x16x16_bf16 v[244:247], v[210:211], v[172:173], v[24:27]
v_rcp_f32 v236, v236
ds_read_b64_tr_b16 a[156:157], v15 offset:8192
buffer_load_dwordx4 v[108:111], v2, s[24:27], s52 offen offset:3072 sc1
v_mfma_f32_16x16x32_bf16 a[116:119], a[140:143], v[132:135], 0
v_mul_f32 v224, v224, v228
v_mul_f32 v225, v225, v228
v_mfma_f32_16x16x16_bf16 v[252:255], v[214:215], v[174:175], v[24:27]
v_mfma_f32_16x16x32_bf16 a[120:123], a[140:143], v[136:139], 0
v_mul_f32 v226, v226, v228
v_mul_f32 v227, v227, v228
ds_read_b64_tr_b16 a[158:159], v15 offset:10240
v_mfma_f32_16x16x32_bf16 a[124:127], a[140:143], v[140:143], 0
v_mul_f32 v232, v232, v236
v_mul_f32 v233, v233, v236
v_mfma_f32_16x16x16_bf16 v[240:243], v[208:209], v[172:173], 0
v_mul_f32 v234, v234, v236
v_mul_f32 v235, v235, v236
s_waitcnt vmcnt(16) lgkmcnt(0)
s_nop 1
v_mfma_f32_16x16x32_bf16 a[64:67], a[144:147], v[144:147], a[64:67]
v_cvt_pk_bf16_f32 v168, v224, v225
v_cvt_pk_bf16_f32 v169, v226, v227
v_mfma_f32_16x16x16_bf16 v[248:251], v[212:213], v[174:175], 0
ds_read_b64_tr_b16 a[128:129], v4 offset:0
s_add_u32 s52, s11, 8192
v_mfma_f32_16x16x32_bf16 a[68:71], a[144:147], v[148:151], a[68:71]
v_cvt_pk_bf16_f32 v170, v232, v233
v_cvt_pk_bf16_f32 v171, v234, v235
buffer_load_dwordx4 v[112:115], v2, s[24:27], s52 offen offset:0 sc1
v_mfma_f32_16x16x32_bf16 a[72:75], a[144:147], v[152:155], a[72:75]
v_rcp_f32 v244, v244
v_mfma_f32_16x16x16_bf16 v[228:231], v[218:219], v[176:177], v[24:27]
v_rcp_f32 v252, v252
ds_read_b64_tr_b16 a[130:131], v4 offset:2048
buffer_load_dwordx4 v[116:119], v2, s[24:27], s52 offen offset:1024 sc1
v_mfma_f32_16x16x32_bf16 a[76:79], a[144:147], v[156:159], a[76:79]
v_mul_f32 v240, v240, v244
v_mul_f32 v241, v241, v244
v_mfma_f32_16x16x16_bf16 v[236:239], v[222:223], v[178:179], v[24:27]
v_mfma_f32_16x16x32_bf16 a[80:83], a[148:151], v[144:147], a[80:83]
v_mul_f32 v242, v242, v244
v_mul_f32 v243, v243, v244
ds_read_b64_tr_b16 a[132:133], v5 offset:0
buffer_load_dwordx4 v[120:123], v2, s[24:27], s52 offen offset:2048 sc1
v_mfma_f32_16x16x32_bf16 a[84:87], a[148:151], v[148:151], a[84:87]
v_mul_f32 v248, v248, v252
v_mul_f32 v249, v249, v252
v_mfma_f32_16x16x16_bf16 v[224:227], v[216:217], v[176:177], 0
v_mul_f32 v250, v250, v252
v_mul_f32 v251, v251, v252
buffer_load_dwordx4 v[124:127], v2, s[24:27], s52 offen offset:3072 sc1
v_mfma_f32_16x16x32_bf16 a[88:91], a[148:151], v[152:155], a[88:91]
v_cvt_pk_bf16_f32 v172, v240, v241
v_cvt_pk_bf16_f32 v173, v242, v243
v_mfma_f32_16x16x16_bf16 v[232:235], v[220:221], v[178:179], 0
ds_read_b64_tr_b16 a[134:135], v5 offset:2048
v_mfma_f32_16x16x32_bf16 a[92:95], a[148:151], v[156:159], a[92:95]
v_cvt_pk_bf16_f32 v174, v248, v249
v_cvt_pk_bf16_f32 v175, v250, v251
s_add_u32 s52, s66, 12288
v_mfma_f32_16x16x32_bf16 a[96:99], a[152:155], v[144:147], a[96:99]
v_rcp_f32 v228, v228
v_mfma_f32_16x16x16_bf16 v[244:247], v[218:219], v[180:181], v[24:27]
v_rcp_f32 v236, v236
ds_read_b64_tr_b16 a[136:137], v6 offset:0
buffer_load_dwordx4 v[32:35], v2, s[24:27], s52 offen offset:0 sc1
v_mfma_f32_16x16x32_bf16 a[100:103], a[152:155], v[148:151], a[100:103]
v_mul_f32 v224, v224, v228
v_mul_f32 v225, v225, v228
v_mfma_f32_16x16x16_bf16 v[252:255], v[222:223], v[182:183], v[24:27]
v_mfma_f32_16x16x32_bf16 a[104:107], a[152:155], v[152:155], a[104:107]
v_mul_f32 v226, v226, v228
v_mul_f32 v227, v227, v228
ds_read_b64_tr_b16 a[138:139], v6 offset:2048
buffer_load_dwordx4 v[40:43], v2, s[24:27], s52 offen offset:1024 sc1
v_mfma_f32_16x16x32_bf16 a[108:111], a[152:155], v[156:159], a[108:111]
v_mul_f32 v232, v232, v236
v_mul_f32 v233, v233, v236
v_mfma_f32_16x16x16_bf16 v[240:243], v[216:217], v[180:181], 0
v_mul_f32 v234, v234, v236
v_mul_f32 v235, v235, v236
s_add_u32 s52, s66, 26624
v_mfma_f32_16x16x32_bf16 a[112:115], a[156:159], v[144:147], a[112:115]
v_cvt_pk_bf16_f32 v176, v224, v225
v_cvt_pk_bf16_f32 v177, v226, v227
v_mfma_f32_16x16x16_bf16 v[248:251], v[220:221], v[182:183], 0
ds_read_b64_tr_b16 a[140:141], v7 offset:0
v_mfma_f32_16x16x32_bf16 a[116:119], a[156:159], v[148:151], a[116:119]
v_cvt_pk_bf16_f32 v178, v232, v233
v_cvt_pk_bf16_f32 v179, v234, v235
buffer_load_dwordx4 v[36:39], v2, s[24:27], s52 offen offset:0 sc1
v_mfma_f32_16x16x32_bf16 a[120:123], a[156:159], v[152:155], a[120:123]
v_rcp_f32 v244, v244
v_mfma_f32_16x16x16_bf16 v[228:231], v[218:219], v[184:185], v[24:27]
v_rcp_f32 v252, v252
ds_read_b64_tr_b16 a[142:143], v7 offset:2048
buffer_load_dwordx4 v[44:47], v2, s[24:27], s52 offen offset:1024 sc1
v_mfma_f32_16x16x32_bf16 a[124:127], a[156:159], v[156:159], a[124:127]
v_mul_f32 v240, v240, v244
v_mul_f32 v241, v241, v244
v_mfma_f32_16x16x16_bf16 v[236:239], v[222:223], v[186:187], v[24:27]
s_waitcnt lgkmcnt(0)
s_nop 1
v_mfma_f32_16x16x32_bf16 a[64:67], a[128:131], v[160:163], a[64:67]
v_mul_f32 v242, v242, v244
v_mul_f32 v243, v243, v244
ds_read_b64_tr_b16 a[144:145], v4 offset:4096
s_add_u32 s52, s66, 40960
v_mfma_f32_16x16x32_bf16 a[68:71], a[128:131], v[164:167], a[68:71]
v_mul_f32 v248, v248, v252
v_mul_f32 v249, v249, v252
v_mfma_f32_16x16x16_bf16 v[224:227], v[216:217], v[184:185], 0
v_mul_f32 v250, v250, v252
v_mul_f32 v251, v251, v252
v_mfma_f32_16x16x32_bf16 a[72:75], a[128:131], v[168:171], a[72:75]
v_cvt_pk_bf16_f32 v180, v240, v241
v_cvt_pk_bf16_f32 v181, v242, v243
v_mfma_f32_16x16x16_bf16 v[232:235], v[220:221], v[186:187], 0
ds_read_b64_tr_b16 a[146:147], v4 offset:6144
buffer_load_dwordx4 v[48:51], v2, s[24:27], s52 offen offset:0 sc1
v_mfma_f32_16x16x32_bf16 a[76:79], a[128:131], v[172:175], a[76:79]
v_cvt_pk_bf16_f32 v182, v248, v249
v_cvt_pk_bf16_f32 v183, v250, v251
v_mfma_f32_16x16x32_bf16 a[80:83], a[132:135], v[160:163], a[80:83]
v_rcp_f32 v228, v228
v_mfma_f32_16x16x16_bf16 v[244:247], v[218:219], v[188:189], v[24:27]
v_rcp_f32 v236, v236
ds_read_b64_tr_b16 a[148:149], v5 offset:4096
v_mfma_f32_16x16x32_bf16 a[84:87], a[132:135], v[164:167], a[84:87]
v_mul_f32 v224, v224, v228
v_mul_f32 v225, v225, v228
v_mfma_f32_16x16x16_bf16 v[252:255], v[222:223], v[190:191], v[24:27]
buffer_load_dwordx4 v[56:59], v2, s[24:27], s52 offen offset:1024 sc1
v_mfma_f32_16x16x32_bf16 a[88:91], a[132:135], v[168:171], a[88:91]
v_mul_f32 v226, v226, v228
v_mul_f32 v227, v227, v228
ds_read_b64_tr_b16 a[150:151], v5 offset:6144
v_mfma_f32_16x16x32_bf16 a[92:95], a[132:135], v[172:175], a[92:95]
v_mul_f32 v232, v232, v236
v_mul_f32 v233, v233, v236
v_mfma_f32_16x16x16_bf16 v[240:243], v[216:217], v[188:189], 0
v_mul_f32 v234, v234, v236
v_mul_f32 v235, v235, v236
v_mfma_f32_16x16x32_bf16 a[96:99], a[136:139], v[160:163], a[96:99]
v_cvt_pk_bf16_f32 v184, v224, v225
v_cvt_pk_bf16_f32 v185, v226, v227
v_mfma_f32_16x16x16_bf16 v[248:251], v[220:221], v[190:191], 0
ds_read_b64_tr_b16 a[152:153], v6 offset:4096
s_add_u32 s52, s66, 55296
v_mfma_f32_16x16x32_bf16 a[100:103], a[136:139], v[164:167], a[100:103]
v_cvt_pk_bf16_f32 v186, v232, v233
v_cvt_pk_bf16_f32 v187, v234, v235
v_mfma_f32_16x16x32_bf16 a[104:107], a[136:139], v[168:171], a[104:107]
v_rcp_f32 v244, v244
v_rcp_f32 v252, v252
ds_read_b64_tr_b16 a[154:155], v6 offset:6144
buffer_load_dwordx4 v[52:55], v2, s[24:27], s52 offen offset:0 sc1
v_mfma_f32_16x16x32_bf16 a[108:111], a[136:139], v[172:175], a[108:111]
v_mul_f32 v240, v240, v244
v_mul_f32 v241, v241, v244
v_mfma_f32_16x16x32_bf16 a[112:115], a[140:143], v[160:163], a[112:115]
v_mul_f32 v242, v242, v244
v_mul_f32 v243, v243, v244
ds_read_b64_tr_b16 a[156:157], v7 offset:4096
v_mfma_f32_16x16x32_bf16 a[116:119], a[140:143], v[164:167], a[116:119]
v_mul_f32 v248, v248, v252
v_mul_f32 v249, v249, v252
v_mul_f32 v250, v250, v252
v_mul_f32 v251, v251, v252
buffer_load_dwordx4 v[60:63], v2, s[24:27], s52 offen offset:1024 sc1
v_mfma_f32_16x16x32_bf16 a[120:123], a[140:143], v[168:171], a[120:123]
v_cvt_pk_bf16_f32 v188, v240, v241
v_cvt_pk_bf16_f32 v189, v242, v243
ds_read_b64_tr_b16 a[158:159], v7 offset:6144
v_mfma_f32_16x16x32_bf16 a[124:127], a[140:143], v[172:175], a[124:127]
v_cvt_pk_bf16_f32 v190, v248, v249
v_cvt_pk_bf16_f32 v191, v250, v251
s_waitcnt lgkmcnt(0)
s_nop 1
v_mfma_f32_16x16x32_bf16 a[64:67], a[144:147], v[176:179], a[64:67]
ds_read_b64_tr_b16 a[128:129], v4 offset:8192
v_mfma_f32_16x16x32_bf16 a[68:71], a[144:147], v[180:183], a[68:71]
v_mfma_f32_16x16x32_bf16 a[72:75], a[144:147], v[184:187], a[72:75]
ds_read_b64_tr_b16 a[130:131], v4 offset:10240
v_mfma_f32_16x16x32_bf16 a[76:79], a[144:147], v[188:191], a[76:79]
v_mfma_f32_16x16x32_bf16 a[80:83], a[148:151], v[176:179], a[80:83]
ds_read_b64_tr_b16 a[132:133], v5 offset:8192
v_mfma_f32_16x16x32_bf16 a[84:87], a[148:151], v[180:183], a[84:87]
v_mfma_f32_16x16x32_bf16 a[88:91], a[148:151], v[184:187], a[88:91]
ds_read_b64_tr_b16 a[134:135], v5 offset:10240
v_mfma_f32_16x16x32_bf16 a[92:95], a[148:151], v[188:191], a[92:95]
v_mfma_f32_16x16x32_bf16 a[96:99], a[152:155], v[176:179], a[96:99]
ds_read_b64_tr_b16 a[136:137], v6 offset:8192
v_mfma_f32_16x16x32_bf16 a[100:103], a[152:155], v[180:183], a[100:103]
v_mfma_f32_16x16x32_bf16 a[104:107], a[152:155], v[184:187], a[104:107]
ds_read_b64_tr_b16 a[138:139], v6 offset:10240
v_mfma_f32_16x16x32_bf16 a[108:111], a[152:155], v[188:191], a[108:111]
v_mfma_f32_16x16x32_bf16 a[112:115], a[156:159], v[176:179], a[112:115]
ds_read_b64_tr_b16 a[140:141], v7 offset:8192
v_mfma_f32_16x16x32_bf16 a[116:119], a[156:159], v[180:183], a[116:119]
v_mfma_f32_16x16x32_bf16 a[120:123], a[156:159], v[184:187], a[120:123]
ds_read_b64_tr_b16 a[142:143], v7 offset:10240
v_mfma_f32_16x16x32_bf16 a[124:127], a[156:159], v[188:191], a[124:127]
s_waitcnt vmcnt(12) lgkmcnt(0)
v_mfma_f32_16x16x32_bf16 a[0:3], a[128:131], v[96:99], a[0:3]
ds_read_b64_tr_b16 a[144:145], v8 offset:0
buffer_load_dwordx4 v[192:195], v3, s[16:19], s68 offen
v_mfma_f32_16x16x32_bf16 a[4:7], a[128:131], v[100:103], a[4:7]
ds_write_b128 v21, a[64:67] offset:0
v_mfma_f32_16x16x32_bf16 a[8:11], a[128:131], v[104:107], a[8:11]
ds_read_b64_tr_b16 a[146:147], v8 offset:2048
v_mfma_f32_16x16x32_bf16 a[12:15], a[128:131], v[108:111], a[12:15]
v_mfma_f32_16x16x32_bf16 a[16:19], a[132:135], v[96:99], a[16:19]
ds_read_b64_tr_b16 a[148:149], v9 offset:0
ds_write_b128 v21, a[68:71] offset:4096
v_mfma_f32_16x16x32_bf16 a[20:23], a[132:135], v[100:103], a[20:23]
v_mfma_f32_16x16x32_bf16 a[24:27], a[132:135], v[104:107], a[24:27]
ds_read_b64_tr_b16 a[150:151], v9 offset:2048
v_mfma_f32_16x16x32_bf16 a[28:31], a[132:135], v[108:111], a[28:31]
ds_write_b128 v21, a[72:75] offset:8192
v_mfma_f32_16x16x32_bf16 a[32:35], a[136:139], v[96:99], a[32:35]
ds_read_b64_tr_b16 a[152:153], v10 offset:0
buffer_load_dwordx4 v[196:199], v3, s[16:19], s69 offen
v_mfma_f32_16x16x32_bf16 a[36:39], a[136:139], v[100:103], a[36:39]
v_mfma_f32_16x16x32_bf16 a[40:43], a[136:139], v[104:107], a[40:43]
ds_read_b64_tr_b16 a[154:155], v10 offset:2048
ds_write_b128 v20, a[76:79] offset:4096
v_mfma_f32_16x16x32_bf16 a[44:47], a[136:139], v[108:111], a[44:47]
v_mfma_f32_16x16x32_bf16 a[48:51], a[140:143], v[96:99], a[48:51]
ds_read_b64_tr_b16 a[156:157], v11 offset:0
v_mfma_f32_16x16x32_bf16 a[52:55], a[140:143], v[100:103], a[52:55]
ds_write_b128 v21, a[80:83] offset:1024
v_mfma_f32_16x16x32_bf16 a[56:59], a[140:143], v[104:107], a[56:59]
ds_read_b64_tr_b16 a[158:159], v11 offset:2048
v_mfma_f32_16x16x32_bf16 a[60:63], a[140:143], v[108:111], a[60:63]
s_waitcnt vmcnt(10) lgkmcnt(0)
v_mfma_f32_16x16x32_bf16 a[0:3], a[144:147], v[112:115], a[0:3]
ds_read_b64_tr_b16 a[128:129], v8 offset:4096
v_mfma_f32_16x16x32_bf16 a[4:7], a[144:147], v[116:119], a[4:7]
ds_write_b128 v21, a[84:87] offset:5120
v_mfma_f32_16x16x32_bf16 a[8:11], a[144:147], v[120:123], a[8:11]
ds_read_b64_tr_b16 a[130:131], v8 offset:6144
v_mfma_f32_16x16x32_bf16 a[12:15], a[144:147], v[124:127], a[12:15]
v_mfma_f32_16x16x32_bf16 a[16:19], a[148:151], v[112:115], a[16:19]
ds_read_b64_tr_b16 a[132:133], v9 offset:4096
ds_write_b128 v21, a[88:91] offset:9216
v_mfma_f32_16x16x32_bf16 a[20:23], a[148:151], v[116:119], a[20:23]
v_mfma_f32_16x16x32_bf16 a[24:27], a[148:151], v[120:123], a[24:27]
ds_read_b64_tr_b16 a[134:135], v9 offset:6144
v_mfma_f32_16x16x32_bf16 a[28:31], a[148:151], v[124:127], a[28:31]
ds_write_b128 v20, a[92:95] offset:5120
v_mfma_f32_16x16x32_bf16 a[32:35], a[152:155], v[112:115], a[32:35]
ds_read_b64_tr_b16 a[136:137], v10 offset:4096
v_mfma_f32_16x16x32_bf16 a[36:39], a[152:155], v[116:119], a[36:39]
v_mfma_f32_16x16x32_bf16 a[40:43], a[152:155], v[120:123], a[40:43]
ds_read_b64_tr_b16 a[138:139], v10 offset:6144
ds_write_b128 v21, a[96:99] offset:2048
v_mfma_f32_16x16x32_bf16 a[44:47], a[152:155], v[124:127], a[44:47]
v_mfma_f32_16x16x32_bf16 a[48:51], a[156:159], v[112:115], a[48:51]
ds_read_b64_tr_b16 a[140:141], v11 offset:4096
v_mfma_f32_16x16x32_bf16 a[52:55], a[156:159], v[116:119], a[52:55]
ds_write_b128 v21, a[100:103] offset:6144
v_mfma_f32_16x16x32_bf16 a[56:59], a[156:159], v[120:123], a[56:59]
ds_read_b64_tr_b16 a[142:143], v11 offset:6144
v_mfma_f32_16x16x32_bf16 a[60:63], a[156:159], v[124:127], a[60:63]
ds_write_b128 v21, a[104:107] offset:10240
s_waitcnt vmcnt(6) lgkmcnt(0)
v_swap_b32 v34, v36
v_swap_b32 v35, v37
v_swap_b32 v42, v44
v_swap_b32 v43, v45
s_nop 1
v_mfma_f32_16x16x32_bf16 a[0:3], a[128:131], v[32:35], a[0:3]
ds_read_b64_tr_b16 a[144:145], v8 offset:8192
v_mfma_f32_16x16x32_bf16 a[4:7], a[128:131], v[36:39], a[4:7]
ds_write_b128 v20, a[108:111] offset:6144
v_mfma_f32_16x16x32_bf16 a[8:11], a[128:131], v[40:43], a[8:11]
ds_read_b64_tr_b16 a[146:147], v8 offset:10240
v_mfma_f32_16x16x32_bf16 a[12:15], a[128:131], v[44:47], a[12:15]
v_mfma_f32_16x16x32_bf16 a[16:19], a[132:135], v[32:35], a[16:19]
ds_read_b64_tr_b16 a[148:149], v9 offset:8192
ds_write_b128 v21, a[112:115] offset:3072
v_mfma_f32_16x16x32_bf16 a[20:23], a[132:135], v[36:39], a[20:23]
v_mfma_f32_16x16x32_bf16 a[24:27], a[132:135], v[40:43], a[24:27]
ds_read_b64_tr_b16 a[150:151], v9 offset:10240
v_mfma_f32_16x16x32_bf16 a[28:31], a[132:135], v[44:47], a[28:31]
ds_write_b128 v21, a[116:119] offset:7168
v_mfma_f32_16x16x32_bf16 a[32:35], a[136:139], v[32:35], a[32:35]
ds_read_b64_tr_b16 a[152:153], v10 offset:8192
v_mfma_f32_16x16x32_bf16 a[36:39], a[136:139], v[36:39], a[36:39]
v_mfma_f32_16x16x32_bf16 a[40:43], a[136:139], v[40:43], a[40:43]
ds_read_b64_tr_b16 a[154:155], v10 offset:10240
ds_write_b128 v21, a[120:123] offset:11264
v_mfma_f32_16x16x32_bf16 a[44:47], a[136:139], v[44:47], a[44:47]
v_mfma_f32_16x16x32_bf16 a[48:51], a[140:143], v[32:35], a[48:51]
ds_read_b64_tr_b16 a[156:157], v11 offset:8192
v_mfma_f32_16x16x32_bf16 a[52:55], a[140:143], v[36:39], a[52:55]
ds_write_b128 v20, a[124:127] offset:7168
v_mfma_f32_16x16x32_bf16 a[56:59], a[140:143], v[40:43], a[56:59]
ds_read_b64_tr_b16 a[158:159], v11 offset:10240
v_mfma_f32_16x16x32_bf16 a[60:63], a[140:143], v[44:47], a[60:63]
s_waitcnt vmcnt(2) lgkmcnt(0)
s_barrier
v_swap_b32 v50, v52
v_swap_b32 v51, v53
v_swap_b32 v58, v60
v_swap_b32 v59, v61
s_nop 1
v_mfma_f32_16x16x32_bf16 a[0:3], a[144:147], v[48:51], a[0:3]
ds_read_b128 v[128:131], v22 offset:0
ds_read_b128 v[132:135], v22 offset:1024
v_mfma_f32_16x16x32_bf16 a[4:7], a[144:147], v[52:55], a[4:7]
ds_read_b128 v[136:139], v22 offset:2048
ds_read_b128 v[140:143], v22 offset:3072
v_mfma_f32_16x16x32_bf16 a[8:11], a[144:147], v[56:59], a[8:11]
ds_read_b128 v[144:147], v22 offset:12288
ds_read_b128 v[148:151], v22 offset:13312
v_mfma_f32_16x16x32_bf16 a[12:15], a[144:147], v[60:63], a[12:15]
ds_read_b128 v[152:155], v22 offset:14336
ds_read_b128 v[156:159], v22 offset:15360
v_mfma_f32_16x16x32_bf16 a[16:19], a[148:151], v[48:51], a[16:19]
ds_read_b128 v[160:163], v22 offset:24576
ds_read_b128 v[164:167], v22 offset:25600
v_mfma_f32_16x16x32_bf16 a[20:23], a[148:151], v[52:55], a[20:23]
ds_read_b128 v[168:171], v22 offset:26624
ds_read_b128 v[172:175], v22 offset:27648
v_mfma_f32_16x16x32_bf16 a[24:27], a[148:151], v[56:59], a[24:27]
ds_read_b128 v[176:179], v22 offset:36864
ds_read_b128 v[180:183], v22 offset:37888
v_mfma_f32_16x16x32_bf16 a[28:31], a[148:151], v[60:63], a[28:31]
ds_read_b128 v[184:187], v22 offset:38912
ds_read_b128 v[188:191], v22 offset:39936
v_mfma_f32_16x16x32_bf16 a[32:35], a[152:155], v[48:51], a[32:35]
v_mfma_f32_16x16x32_bf16 a[36:39], a[152:155], v[52:55], a[36:39]
v_mfma_f32_16x16x32_bf16 a[40:43], a[152:155], v[56:59], a[40:43]
v_mfma_f32_16x16x32_bf16 a[44:47], a[152:155], v[60:63], a[44:47]
v_mfma_f32_16x16x32_bf16 a[48:51], a[156:159], v[48:51], a[48:51]
v_mul_f32 v19, 0xbfb8aa3b, v18
v_mfma_f32_16x16x32_bf16 a[52:55], a[156:159], v[52:55], a[52:55]
v_mfma_f32_16x16x32_bf16 a[56:59], a[156:159], v[56:59], a[56:59]
v_mfma_f32_16x16x32_bf16 a[60:63], a[156:159], v[60:63], a[60:63]
s_waitcnt vmcnt(0) lgkmcnt(0)
v_add_f32 v128, v128, v144
v_add_f32 v160, v160, v176
v_add_f32 v129, v129, v145
v_add_f32 v161, v161, v177
v_add_f32 v130, v130, v146
ds_write_b128 v20, a[0:3] offset:49152
v_add_f32 v162, v162, v178
v_add_f32 v131, v131, v147
v_add_f32 v163, v163, v179
v_add_f32 v132, v132, v148
v_add_f32 v164, v164, v180
ds_write_b128 v20, a[4:7] offset:53248
v_add_f32 v133, v133, v149
v_add_f32 v165, v165, v181
v_add_f32 v134, v134, v150
v_add_f32 v166, v166, v182
v_add_f32 v135, v135, v151
ds_write_b128 v20, a[8:11] offset:57344
v_add_f32 v167, v167, v183
v_add_f32 v136, v136, v152
v_add_f32 v168, v168, v184
v_add_f32 v137, v137, v153
v_add_f32 v169, v169, v185
ds_write_b128 v20, a[12:15] offset:0
v_add_f32 v138, v138, v154
v_add_f32 v170, v170, v186
v_add_f32 v139, v139, v155
v_add_f32 v171, v171, v187
v_add_f32 v140, v140, v156
ds_write_b128 v20, a[16:19] offset:50176
v_add_f32 v172, v172, v188
v_add_f32 v141, v141, v157
v_add_f32 v173, v173, v189
v_add_f32 v142, v142, v158
v_add_f32 v174, v174, v190
ds_write_b128 v20, a[20:23] offset:54272
v_add_f32 v143, v143, v159
v_add_f32 v175, v175, v191
v_add_f32 v128, v128, v160
v_add_f32 v129, v129, v161
v_add_f32 v130, v130, v162
ds_write_b128 v20, a[24:27] offset:58368
v_add_f32 v131, v131, v163
v_add_f32 v132, v132, v164
v_add_f32 v133, v133, v165
v_add_f32 v134, v134, v166
v_add_f32 v135, v135, v167
ds_write_b128 v20, a[28:31] offset:1024
v_add_f32 v136, v136, v168
v_add_f32 v137, v137, v169
v_add_f32 v138, v138, v170
v_add_f32 v139, v139, v171
v_add_f32 v140, v140, v172
ds_write_b128 v20, a[32:35] offset:51200
v_add_f32 v141, v141, v173
v_add_f32 v142, v142, v174
v_add_f32 v143, v143, v175
v_mul_f32 v32, v18, v128
v_mul_f32 v33, v18, v129
ds_write_b128 v20, a[36:39] offset:55296
v_mul_f32 v34, v18, v130
v_mul_f32 v35, v18, v131
v_mul_f32 v36, v18, v132
v_mul_f32 v37, v18, v133
v_mul_f32 v38, v18, v134
ds_write_b128 v20, a[40:43] offset:59392
v_mul_f32 v39, v18, v135
v_mul_f32 v40, v18, v136
v_mul_f32 v41, v18, v137
v_mul_f32 v42, v18, v138
v_mul_f32 v43, v18, v139
ds_write_b128 v20, a[44:47] offset:2048
v_mul_f32 v44, v18, v140
v_mul_f32 v45, v18, v141
v_mul_f32 v46, v18, v142
v_mul_f32 v47, v18, v143
v_lshlrev_b32 v208, 16, v192
ds_write_b128 v20, a[48:51] offset:52224
v_and_b32 v209, 0xffff0000, v192
v_lshlrev_b32 v210, 16, v193
v_and_b32 v211, 0xffff0000, v193
v_lshlrev_b32 v212, 16, v194
v_and_b32 v213, 0xffff0000, v194
ds_write_b128 v20, a[52:55] offset:56320
v_lshlrev_b32 v214, 16, v195
v_and_b32 v215, 0xffff0000, v195
v_lshlrev_b32 v216, 16, v196
v_and_b32 v217, 0xffff0000, v196
v_lshlrev_b32 v218, 16, v197
ds_write_b128 v20, a[56:59] offset:60416
v_and_b32 v219, 0xffff0000, v197
v_lshlrev_b32 v220, 16, v198
v_and_b32 v221, 0xffff0000, v198
v_lshlrev_b32 v222, 16, v199
v_and_b32 v223, 0xffff0000, v199
ds_write_b128 v20, a[60:63] offset:3072
s_waitcnt lgkmcnt(0)
s_barrier
ds_read_b128 v[64:67], v23 offset:0
ds_read_b128 v[80:83], v23 offset:12288
ds_read_b128 v[96:99], v23 offset:24576
ds_read_b128 v[112:115], v23 offset:36864
ds_read_b128 v[68:71], v23 offset:1024
ds_read_b128 v[84:87], v23 offset:13312
ds_read_b128 v[100:103], v23 offset:25600
ds_read_b128 v[116:119], v23 offset:37888
ds_read_b128 v[72:75], v23 offset:2048
ds_read_b128 v[88:91], v23 offset:14336
ds_read_b128 v[104:107], v23 offset:26624
ds_read_b128 v[120:123], v23 offset:38912
ds_read_b128 v[76:79], v23 offset:3072
ds_read_b128 v[92:95], v23 offset:15360
ds_read_b128 v[108:111], v23 offset:27648
ds_read_b128 v[124:127], v23 offset:39936
s_waitcnt lgkmcnt(12)
v_add_f32 v64, v64, v80
v_add_f32 v96, v96, v112
v_add_f32 v65, v65, v81
v_add_f32 v97, v97, v113
v_add_f32 v66, v66, v82
v_add_f32 v98, v98, v114
v_add_f32 v67, v67, v83
v_add_f32 v99, v99, v115
v_add_f32 v64, v64, v96
v_add_f32 v65, v65, v97
v_add_f32 v66, v66, v98
v_add_f32 v67, v67, v99
v_mul_f32 v48, v19, v64
v_mul_f32 v49, v19, v65
v_mul_f32 v50, v19, v66
v_mul_f32 v51, v19, v67
v_exp_f32 v48, v48
v_mul_f32 v32, v32, v64
v_exp_f32 v49, v49
v_mul_f32 v33, v33, v65
v_exp_f32 v50, v50
v_mul_f32 v34, v34, v66
v_exp_f32 v51, v51
v_mul_f32 v35, v35, v67
v_add_f32 v48, 1.0, v48
v_add_f32 v49, 1.0, v49
v_add_f32 v50, 1.0, v50
v_add_f32 v51, 1.0, v51
v_rcp_f32 v48, v48
v_rcp_f32 v49, v49
v_rcp_f32 v50, v50
v_rcp_f32 v51, v51
v_mul_f32 v32, v32, v48
v_mul_f32 v33, v33, v49
v_mul_f32 v34, v34, v50
v_mul_f32 v35, v35, v51
v_cvt_pk_bf16_f32 v128, v32, v33
v_cvt_pk_bf16_f32 v129, v34, v35
ds_write_b64 v16, v[128:129] offset:0
s_waitcnt lgkmcnt(9)
v_add_f32 v68, v68, v84
v_add_f32 v100, v100, v116
v_add_f32 v69, v69, v85
v_add_f32 v101, v101, v117
v_add_f32 v70, v70, v86
v_add_f32 v102, v102, v118
v_add_f32 v71, v71, v87
v_add_f32 v103, v103, v119
v_add_f32 v68, v68, v100
v_add_f32 v69, v69, v101
v_add_f32 v70, v70, v102
v_add_f32 v71, v71, v103
v_mul_f32 v52, v19, v68
v_mul_f32 v53, v19, v69
v_mul_f32 v54, v19, v70
v_mul_f32 v55, v19, v71
v_exp_f32 v52, v52
v_mul_f32 v36, v36, v68
v_exp_f32 v53, v53
v_mul_f32 v37, v37, v69
v_exp_f32 v54, v54
v_mul_f32 v38, v38, v70
v_exp_f32 v55, v55
v_mul_f32 v39, v39, v71
v_add_f32 v52, 1.0, v52
v_add_f32 v53, 1.0, v53
v_add_f32 v54, 1.0, v54
v_add_f32 v55, 1.0, v55
v_rcp_f32 v52, v52
v_rcp_f32 v53, v53
v_rcp_f32 v54, v54
v_rcp_f32 v55, v55
v_mul_f32 v36, v36, v52
v_mul_f32 v37, v37, v53
v_mul_f32 v38, v38, v54
v_mul_f32 v39, v39, v55
v_cvt_pk_bf16_f32 v130, v36, v37
v_cvt_pk_bf16_f32 v131, v38, v39
ds_write_b64 v16, v[130:131] offset:32
s_waitcnt lgkmcnt(6)
v_add_f32 v72, v72, v88
v_add_f32 v104, v104, v120
v_add_f32 v73, v73, v89
v_add_f32 v105, v105, v121
v_add_f32 v74, v74, v90
v_add_f32 v106, v106, v122
v_add_f32 v75, v75, v91
v_add_f32 v107, v107, v123
v_add_f32 v72, v72, v104
v_add_f32 v73, v73, v105
v_add_f32 v74, v74, v106
v_add_f32 v75, v75, v107
v_mul_f32 v56, v19, v72
v_mul_f32 v57, v19, v73
v_mul_f32 v58, v19, v74
v_mul_f32 v59, v19, v75
v_exp_f32 v56, v56
v_mul_f32 v40, v40, v72
v_exp_f32 v57, v57
v_mul_f32 v41, v41, v73
v_exp_f32 v58, v58
v_mul_f32 v42, v42, v74
v_exp_f32 v59, v59
v_mul_f32 v43, v43, v75
v_add_f32 v56, 1.0, v56
v_add_f32 v57, 1.0, v57
v_add_f32 v58, 1.0, v58
v_add_f32 v59, 1.0, v59
v_rcp_f32 v56, v56
v_rcp_f32 v57, v57
v_rcp_f32 v58, v58
v_rcp_f32 v59, v59
v_mul_f32 v40, v40, v56
v_mul_f32 v41, v41, v57
v_mul_f32 v42, v42, v58
v_mul_f32 v43, v43, v59
v_cvt_pk_bf16_f32 v132, v40, v41
v_cvt_pk_bf16_f32 v133, v42, v43
ds_write_b64 v16, v[132:133] offset:64
s_waitcnt lgkmcnt(3)
v_add_f32 v76, v76, v92
v_add_f32 v108, v108, v124
v_add_f32 v77, v77, v93
v_add_f32 v109, v109, v125
v_add_f32 v78, v78, v94
v_add_f32 v110, v110, v126
v_add_f32 v79, v79, v95
v_add_f32 v111, v111, v127
v_add_f32 v76, v76, v108
v_add_f32 v77, v77, v109
v_add_f32 v78, v78, v110
v_add_f32 v79, v79, v111
v_mul_f32 v60, v19, v76
v_mul_f32 v61, v19, v77
v_mul_f32 v62, v19, v78
v_mul_f32 v63, v19, v79
v_exp_f32 v60, v60
v_mul_f32 v44, v44, v76
v_exp_f32 v61, v61
v_mul_f32 v45, v45, v77
v_exp_f32 v62, v62
v_mul_f32 v46, v46, v78
v_exp_f32 v63, v63
v_mul_f32 v47, v47, v79
v_add_f32 v60, 1.0, v60
v_add_f32 v61, 1.0, v61
v_add_f32 v62, 1.0, v62
v_add_f32 v63, 1.0, v63
v_rcp_f32 v60, v60
v_rcp_f32 v61, v61
v_rcp_f32 v62, v62
v_rcp_f32 v63, v63
v_mul_f32 v44, v44, v60
v_mul_f32 v45, v45, v61
v_mul_f32 v46, v46, v62
v_mul_f32 v47, v47, v63
v_cvt_pk_bf16_f32 v134, v44, v45
v_cvt_pk_bf16_f32 v135, v46, v47
ds_write_b64 v16, v[134:135] offset:96
s_waitcnt lgkmcnt(0)
ds_read_b128 v[32:35], v17
ds_read_b128 v[36:39], v17 offset:1152
s_waitcnt lgkmcnt(1)
v_lshlrev_b32 v40, 16, v32
v_and_b32 v41, 0xffff0000, v32
v_add_f32 v40, v40, v208
v_add_f32 v41, v41, v209
v_cvt_pk_bf16_f32 v32, v40, v41
v_lshlrev_b32 v40, 16, v33
v_and_b32 v41, 0xffff0000, v33
v_add_f32 v40, v40, v210
v_add_f32 v41, v41, v211
v_cvt_pk_bf16_f32 v33, v40, v41
v_lshlrev_b32 v40, 16, v34
v_and_b32 v41, 0xffff0000, v34
v_add_f32 v40, v40, v212
v_add_f32 v41, v41, v213
v_cvt_pk_bf16_f32 v34, v40, v41
v_lshlrev_b32 v40, 16, v35
v_and_b32 v41, 0xffff0000, v35
v_add_f32 v40, v40, v214
v_add_f32 v41, v41, v215
v_cvt_pk_bf16_f32 v35, v40, v41
buffer_store_dwordx4 v[32:35], v3, s[32:35], s68 offen
s_waitcnt lgkmcnt(0)
v_lshlrev_b32 v40, 16, v36
v_and_b32 v41, 0xffff0000, v36
v_add_f32 v40, v40, v216
v_add_f32 v41, v41, v217
v_cvt_pk_bf16_f32 v36, v40, v41
v_lshlrev_b32 v40, 16, v37
v_and_b32 v41, 0xffff0000, v37
v_add_f32 v40, v40, v218
v_add_f32 v41, v41, v219
v_cvt_pk_bf16_f32 v37, v40, v41
v_lshlrev_b32 v40, 16, v38
v_and_b32 v41, 0xffff0000, v38
v_add_f32 v40, v40, v220
v_add_f32 v41, v41, v221
v_cvt_pk_bf16_f32 v38, v40, v41
v_lshlrev_b32 v40, 16, v39
v_and_b32 v41, 0xffff0000, v39
v_add_f32 v40, v40, v222
v_add_f32 v41, v41, v223
v_cvt_pk_bf16_f32 v39, v40, v41
buffer_store_dwordx4 v[36:39], v3, s[32:35], s69 offen
s_endpgm
L_nspinh:
v_mov_b32 v10, 0
buffer_load_dword v93, v10, s[28:31], 0 offen sc1
s_waitcnt vmcnt(0)
v_readfirstlane_b32 s60, v93
s_cmp_lg_u32 s60, 0
s_cbranch_scc1 L_nbackh
s_add_u32 s61, s61, 1
s_cmp_lt_u32 s61, 20000
s_cbranch_scc1 L_nspinh
s_branch L_nbackh
L_creh:
s_add_u32 s61, s61, 1
s_cmp_ge_u32 s61, 20000
s_cbranch_scc1 L_cokh
buffer_load_dwordx2 v[56:57], v94, s[24:27], s56 offen offset:0 sc1
buffer_load_dwordx2 v[58:59], v94, s[24:27], s56 offen offset:128 sc1
buffer_load_dwordx2 v[60:61], v94, s[24:27], s56 offen offset:256 sc1
buffer_load_dwordx2 v[62:63], v94, s[24:27], s56 offen offset:384 sc1
buffer_load_dwordx4 v[64:67], v95, s[24:27], s57 offen offset:0 sc1
buffer_load_dwordx4 v[68:71], v95, s[24:27], s57 offen offset:1024 sc1
buffer_load_dwordx4 v[72:75], v95, s[24:27], s57 offen offset:2048 sc1
buffer_load_dwordx4 v[76:79], v95, s[24:27], s57 offen offset:3072 sc1
s_add_u32 s52, s57, 4096
buffer_load_dwordx4 v[80:83], v95, s[24:27], s52 offen offset:0 sc1
buffer_load_dwordx4 v[84:87], v95, s[24:27], s52 offen offset:1024 sc1
buffer_load_dwordx4 v[88:91], v95, s[24:27], s52 offen offset:2048 sc1
s_waitcnt vmcnt(0)
s_branch L_cchkh
L_nspinq:
v_mov_b32 v10, 0
buffer_load_dword v93, v10, s[28:31], 0 offen sc1
s_waitcnt vmcnt(0)
v_readfirstlane_b32 s60, v93
s_cmp_lg_u32 s60, 0
s_cbranch_scc1 L_nbackq
s_add_u32 s61, s61, 1
s_cmp_lt_u32 s61, 20000
s_cbranch_scc1 L_nspinq
s_branch L_nbackq
L_creq:
s_add_u32 s61, s61, 1
s_cmp_ge_u32 s61, 20000
s_cbranch_scc1 L_cokq
buffer_load_dwordx2 v[56:57], v94, s[24:27], s56 offen offset:0 sc1
buffer_load_dwordx2 v[58:59], v94, s[24:27], s56 offen offset:128 sc1
buffer_load_dwordx2 v[60:61], v94, s[24:27], s56 offen offset:256 sc1
buffer_load_dwordx2 v[62:63], v94, s[24:27], s56 offen offset:384 sc1
buffer_load_dwordx4 v[64:67], v95, s[24:27], s57 offen offset:0 sc1
buffer_load_dwordx4 v[68:71], v95, s[24:27], s57 offen offset:1024 sc1
buffer_load_dwordx4 v[72:75], v95, s[24:27], s57 offen offset:2048 sc1
buffer_load_dwordx4 v[76:79], v95, s[24:27], s57 offen offset:3072 sc1
s_add_u32 s52, s57, 4096
buffer_load_dwordx4 v[80:83], v95, s[24:27], s52 offen offset:0 sc1
buffer_load_dwordx4 v[84:87], v95, s[24:27], s52 offen offset:1024 sc1
s_waitcnt vmcnt(0)
s_branch L_cchkq
L_pqp:
s_add_u32 s61, s61, 1
s_cmp_ge_u32 s61, 20000
s_cbranch_scc1 L_pqok
buffer_load_dword v17, v16, s[24:27], s64 offen sc1
s_branch L_p2w
L_kfre:
s_add_u32 s61, s61, 1
s_cmp_ge_u32 s61, 20000
s_cbranch_scc1 L_kfok
buffer_load_dwordx4 v[192:195], v2, s[24:27], s62 offen offset:0 sc1
buffer_load_dwordx4 v[196:199], v2, s[24:27], s62 offen offset:1024 sc1
buffer_load_dwordx4 v[200:203], v2, s[24:27], s62 offen offset:2048 sc1
buffer_load_dwordx4 v[204:207], v2, s[24:27], s62 offen offset:3072 sc1
buffer_load_dwordx4 v[208:211], v2, s[24:27], s49 offen offset:0 sc1
buffer_load_dwordx4 v[212:215], v2, s[24:27], s49 offen offset:1024 sc1
buffer_load_dwordx4 v[216:219], v2, s[24:27], s49 offen offset:2048 sc1
buffer_load_dwordx4 v[220:223], v2, s[24:27], s49 offen offset:3072 sc1
buffer_load_dwordx4 v[28:31], v23, s[24:27], s65 offen sc1
buffer_load_dwordx2 v[18:19], v0, s[24:27], s48 offen sc1
s_waitcnt vmcnt(0)
v_min3_u32 v224, v193, v195, v197
v_max3_u32 v225, v193, v195, v197
v_min3_u32 v224, v224, v199, v201
v_max3_u32 v225, v225, v199, v201
v_min3_u32 v224, v224, v203, v205
v_max3_u32 v225, v225, v203, v205
v_min3_u32 v224, v224, v207, v209
v_max3_u32 v225, v225, v207, v209
v_min3_u32 v224, v224, v211, v213
v_max3_u32 v225, v225, v211, v213
v_min3_u32 v224, v224, v215, v217
v_max3_u32 v225, v225, v215, v217
v_min3_u32 v224, v224, v219, v221
v_max3_u32 v225, v225, v219, v221
v_min3_u32 v224, v224, v223, v29
v_max3_u32 v225, v225, v223, v29
v_min3_u32 v224, v224, v31, v19
v_max3_u32 v225, v225, v31, v19
v_cmp_ne_u32 vcc, s60, v224
v_cmp_ne_u32 s[58:59], s60, v225
s_or_b64 vcc, vcc, s[58:59]
s_cbranch_vccnz L_kfre
s_branch L_kfok
L_end:
s_endpgm
.section .rodata,"a"
.p2align 6
.amdhsa_kernel recurrent_scan__linear_attn_block__dense_activation_relu__prompt_kernel
  .amdhsa_next_free_vgpr 512
  .amdhsa_next_free_sgpr 102
  .amdhsa_accum_offset 256
  .amdhsa_group_segment_fixed_size 0
  .amdhsa_kernarg_size 72
  .amdhsa_user_sgpr_count 2
  .amdhsa_user_sgpr_kernarg_segment_ptr 1
  .amdhsa_system_sgpr_workgroup_id_x 1
.end_amdhsa_kernel
```
